```python
import torch

def _softmax(x, axis=-1):
    return torch.softmax(x, dim=axis)
def _gelu(x):
    return torch.nn.functional.gelu(x, approximate="tanh")
def _silu(x):
    return torch.nn.functional.silu(x)
def _sigmoid(x):
    return torch.sigmoid(x)
def _layernorm(x, axis=-1, eps=1e-5):
    m = x.mean(dim=axis, keepdim=True)
    v = x.var(dim=axis, keepdim=True, unbiased=False)
    return (x - m) / torch.sqrt(v + eps)
def _scatter_add(tgt, idx, src, axis=0):
    return tgt.clone().index_add_(axis, idx, src)
def _segment_sum(src, seg, n):
    out = torch.zeros((n,) + src.shape[1:], dtype=src.dtype)
    return out.index_add_(0, seg, src)
def _pad(x, pw):
    flat = tuple(v for pair in reversed(pw) for v in pair)
    return torch.nn.functional.pad(x, flat)

kernel_name = 'gated_mix__softmax_full_mha__dense_activation_mish__prompt'

def setup_inputs():

    _w = (lambda a: (lambda t: t.to(torch.bfloat16) if t.is_floating_point() else t)(torch.as_tensor(a)))
    def _A_setup():
        B, S, D = 1, 2048, 640
        return {
            "x": _w((lambda *s: torch.randn(*s, dtype=torch.bfloat16) * 0.05)(B, S, D)),
            "wqkv": _w((lambda *s: torch.randn(*s, dtype=torch.bfloat16) * 0.8)(D, 3 * D)),
            "wo": _w((lambda *s: torch.randn(*s, dtype=torch.bfloat16) * 0.05)(D, D)),
        }
    _A_in = _A_setup()

    def _B_setup():
        B, S, D, F = 1, 2048, 640, 1536
        return {
            "x": _w((lambda *s: torch.randn(*s, dtype=torch.bfloat16) * 0.05)(B, S, D)),
            "w1": _w((lambda *s: torch.randn(*s, dtype=torch.bfloat16) * 12.8)(D, F) * (D ** -0.5)),
            "b1": _w((lambda *s: torch.randn(*s, dtype=torch.bfloat16) * 0.2)(F)),
            "w2": _w((lambda *s: torch.randn(*s, dtype=torch.bfloat16) * 0.2)(F, D) * (F ** -0.5)),
        }
    _B_in = _B_setup()

    return {
        "A_x": _A_in["x"],
        "A_wqkv": _A_in["wqkv"],
        "A_wo": _A_in["wo"],
        "B_x": _B_in["x"],
        "B_w1": _B_in["w1"],
        "B_b1": _B_in["b1"],
        "B_w2": _B_in["w2"],
        "gate_w": _w((lambda *s: torch.randn(*s, dtype=torch.bfloat16) * 0.05)(640) * 16.0),
    }

def reference(A_x, A_wqkv, A_wo, B_x, B_w1, B_b1, B_w2, gate_w):
    def _A_ref(x, wqkv, wo):
        B, S, D = x.shape
        H = 32; Dh = D // H
        qkv = (lambda x, *d: x.permute(*d))((x @ wqkv).reshape(B, S, 3, H, Dh), 2, 0, 3, 1, 4)
        q, k, v = qkv[0], qkv[1], qkv[2]
        scale = Dh ** -0.5
        scores = torch.einsum("bhqd,bhkd->bhqk", q, k) * scale
        p = _softmax(scores, axis=-1)
        o = torch.einsum("bhqk,bhkd->bhqd", p, v)
        return (lambda x, *d: x.permute(*d))(o, 0, 2, 1, 3).reshape(B, S, D) @ wo

    def _B_ref(x, w1, b1, w2):
        h = torch.einsum("bsd,df->bsf", x, w1) + b1
        sp = torch.log1p(torch.exp(-torch.abs(h))) + torch.where(h > 0, h, torch.zeros_like(h))
        act = h * torch.tanh(sp)
        return torch.einsum("bsf,fd->bsd", act, w2)

    x = A_x
    g = _sigmoid((x * gate_w).sum(-1, keepdims=True))
    a = _A_ref(x, A_wqkv, A_wo)
    b = _B_ref(x, B_w1, B_b1, B_w2)
    return g * a + (1 - g) * b
```

```asm
; @launch kernel=k1_kernel grid=(256,1,1) block=(768,1,1) lds=160128
; @launch kernel=attn_kernel grid=(256,1,1) block=(768,1,1) lds=154624
.amdgcn_target "amdgcn-amd-amdhsa--gfx950"
.text
.globl k1_kernel
.p2align 8
.type k1_kernel,@function
k1_kernel:
    s_cmp_ge_u32 s2, 256
    s_cbranch_scc1 L_k1_end
    s_load_dwordx4 s[8:11], s[0:1], 0
    s_load_dwordx4 s[16:19], s[0:1], 32
    s_load_dwordx2 s[44:45], s[0:1], 56
    s_load_dwordx2 s[4:5], s[0:1], 80
    v_lshrrev_b32 v1, 6, v0
    s_and_b32 s28, s2, 7
    s_lshr_b32 s29, s2, 3
    v_readfirstlane_b32 s24, v1
    v_mov_b32 v2, 160064
    v_mov_b32 v3, 0
    ds_write_b32 v2, v3
    s_waitcnt lgkmcnt(0)
    s_barrier
    s_and_b32 s25, s28, 1
    s_lshl_b32 s25, s25, 3
    s_and_b32 s36, s29, 7
    s_add_u32 s25, s25, s36
    s_lshr_b32 s26, s28, 1
    s_lshl_b32 s26, s26, 2
    s_lshr_b32 s36, s29, 3
    s_add_u32 s26, s26, s36
    s_waitcnt lgkmcnt(0)
    s_mov_b32 s12, s10
    s_mov_b32 s13, s11
    s_mov_b32 s20, s18
    s_mov_b32 s21, s19
    s_cmp_ge_u32 s24, 8
    s_cbranch_scc1 L_k1_prod
    v_and_b32 v116, 63, v0
    v_and_b32 v117, 31, v116
    v_lshrrev_b32 v118, 5, v116
    s_and_b32 s27, s24, 3
    s_lshr_b32 s28, s24, 2
    s_mov_b32 s6, 22194176
    s_mov_b32 s7, 0x20000
    s_mov_b32 s10, 2621440
    s_mov_b32 s11, 0x20000
    s_mov_b32 s14, 2457600
    s_mov_b32 s15, 0x20000
    s_mov_b32 s18, 1966080
    s_mov_b32 s19, 0x20000
    s_mov_b32 s22, 3072
    s_mov_b32 s23, 0x20000
    s_mov_b32 s46, 1280
    s_mov_b32 s47, 0x20000
    s_cmp_ge_u32 s24, 5
    s_cbranch_scc1 L_pfl_done
    s_mov_b32 s36, 80
    s_mov_b32 s48, s8
    s_mov_b32 s49, s9
    s_cmp_ge_u32 s24, 2
    s_cselect_b32 s36, 75, s36
    s_cselect_b32 s48, s12, s48
    s_cselect_b32 s49, s13, s49
    s_cmp_ge_u32 s24, 4
    s_cselect_b32 s36, 60, s36
    s_cselect_b32 s48, s16, s48
    s_cselect_b32 s49, s17, s49
    s_and_b32 s37, s24, 1
    s_lshl_b32 s37, s37, 6
    s_sub_u32 s39, s36, 1
    v_add_u32 v119, s37, v116
    v_min_u32 v119, s39, v119
    s_mul_i32 s38, s2, s36
    v_add_u32 v119, s38, v119
    v_lshlrev_b32 v119, 7, v119
    global_load_dword v128, v119, s[48:49]
L_pfl_done:
    s_lshl_b32 s36, s27, 12
    v_lshlrev_b32 v119, 7, v117
    v_add_u32 v119, s36, v119
    v_bfe_u32 v120, v117, 1, 3
    v_add_u32 v121, 0, v118
    v_xor_b32 v121, v121, v120
    v_lshl_add_u32 v104, v121, 4, v119
    v_add_u32 v121, 2, v118
    v_xor_b32 v121, v121, v120
    v_lshl_add_u32 v105, v121, 4, v119
    v_add_u32 v121, 4, v118
    v_xor_b32 v121, v121, v120
    v_lshl_add_u32 v106, v121, 4, v119
    v_add_u32 v121, 6, v118
    v_xor_b32 v121, v121, v120
    v_lshl_add_u32 v107, v121, 4, v119
    v_bfe_u32 v119, v116, 2, 2
    v_bfe_u32 v120, v116, 4, 1
    v_and_b32 v121, 3, v116
    v_lshlrev_b32 v120, 5, v120
    v_lshl_add_u32 v120, v121, 3, v120
    v_lshl_add_u32 v121, v118, 3, v119
    s_cmp_eq_u32 s28, 0
    s_cbranch_scc0 L_k1_part1
    v_mul_u32_u24 v108, 192, v121
    v_add_u32 v108, v108, v120
    v_add_u32 v108, 118784, v108
    v_lshlrev_b32 v119, 3, v118
    s_mul_i32 s36, s26, 192
    buffer_load_dwordx2 v[72:73], v119, s[20:23], s36 offen offset:0
    buffer_load_dwordx2 v[74:75], v119, s[20:23], s36 offen offset:16
    buffer_load_dwordx2 v[76:77], v119, s[20:23], s36 offen offset:32
    buffer_load_dwordx2 v[78:79], v119, s[20:23], s36 offen offset:48
    buffer_load_dwordx2 v[80:81], v119, s[20:23], s36 offen offset:64
    buffer_load_dwordx2 v[82:83], v119, s[20:23], s36 offen offset:80
    buffer_load_dwordx2 v[84:85], v119, s[20:23], s36 offen offset:96
    buffer_load_dwordx2 v[86:87], v119, s[20:23], s36 offen offset:112
    buffer_load_dwordx2 v[88:89], v119, s[20:23], s36 offen offset:128
    buffer_load_dwordx2 v[90:91], v119, s[20:23], s36 offen offset:144
    buffer_load_dwordx2 v[92:93], v119, s[20:23], s36 offen offset:160
    buffer_load_dwordx2 v[94:95], v119, s[20:23], s36 offen offset:176
    s_waitcnt vmcnt(0)
    v_lshlrev_b32 v0, 16, v72
    v_and_b32 v1, 0xffff0000, v72
    v_lshlrev_b32 v2, 16, v73
    v_and_b32 v3, 0xffff0000, v73
    v_lshlrev_b32 v4, 16, v74
    v_and_b32 v5, 0xffff0000, v74
    v_lshlrev_b32 v6, 16, v75
    v_and_b32 v7, 0xffff0000, v75
    v_lshlrev_b32 v8, 16, v76
    v_and_b32 v9, 0xffff0000, v76
    v_lshlrev_b32 v10, 16, v77
    v_and_b32 v11, 0xffff0000, v77
    v_lshlrev_b32 v12, 16, v78
    v_and_b32 v13, 0xffff0000, v78
    v_lshlrev_b32 v14, 16, v79
    v_and_b32 v15, 0xffff0000, v79
    v_lshlrev_b32 v16, 16, v80
    v_and_b32 v17, 0xffff0000, v80
    v_lshlrev_b32 v18, 16, v81
    v_and_b32 v19, 0xffff0000, v81
    v_lshlrev_b32 v20, 16, v82
    v_and_b32 v21, 0xffff0000, v82
    v_lshlrev_b32 v22, 16, v83
    v_and_b32 v23, 0xffff0000, v83
    v_lshlrev_b32 v24, 16, v84
    v_and_b32 v25, 0xffff0000, v84
    v_lshlrev_b32 v26, 16, v85
    v_and_b32 v27, 0xffff0000, v85
    v_lshlrev_b32 v28, 16, v86
    v_and_b32 v29, 0xffff0000, v86
    v_lshlrev_b32 v30, 16, v87
    v_and_b32 v31, 0xffff0000, v87
    v_lshlrev_b32 v32, 16, v88
    v_and_b32 v33, 0xffff0000, v88
    v_lshlrev_b32 v34, 16, v89
    v_and_b32 v35, 0xffff0000, v89
    v_lshlrev_b32 v36, 16, v90
    v_and_b32 v37, 0xffff0000, v90
    v_lshlrev_b32 v38, 16, v91
    v_and_b32 v39, 0xffff0000, v91
    v_lshlrev_b32 v40, 16, v92
    v_and_b32 v41, 0xffff0000, v92
    v_lshlrev_b32 v42, 16, v93
    v_and_b32 v43, 0xffff0000, v93
    v_lshlrev_b32 v44, 16, v94
    v_and_b32 v45, 0xffff0000, v94
    v_lshlrev_b32 v46, 16, v95
    v_and_b32 v47, 0xffff0000, v95
    v_mov_b32 v119, 160064
    s_mov_b32 s36, 1000000
L_k1_poll_ffn:
    ds_read_b32 v120, v119
    s_waitcnt lgkmcnt(0)
    v_readfirstlane_b32 s37, v120
    s_cmp_ge_u32 s37, 4
    s_cbranch_scc1 L_k1_go_ffn
    s_sub_u32 s36, s36, 1
    s_cmp_eq_u32 s36, 0
    s_cbranch_scc1 L_k1_go_ffn
    s_sleep 1
    s_branch L_k1_poll_ffn
L_k1_go_ffn:
    ds_read_b128 v[64:67], v104 offset:0
    ds_read_b64_tr_b16 v[72:73], v108 offset:0
    ds_read_b64_tr_b16 v[74:75], v108 offset:768
    ds_read_b64_tr_b16 v[76:77], v108 offset:64
    ds_read_b64_tr_b16 v[78:79], v108 offset:832
    ds_read_b64_tr_b16 v[80:81], v108 offset:128
    ds_read_b64_tr_b16 v[82:83], v108 offset:896
    s_waitcnt lgkmcnt(0)
    v_mfma_f32_32x32x16_bf16 v[0:15], v[72:75], v[64:67], v[0:15]
    ds_read_b128 v[68:71], v105 offset:0
    ds_read_b64_tr_b16 v[88:89], v108 offset:3072
    ds_read_b64_tr_b16 v[90:91], v108 offset:3840
    v_mfma_f32_32x32x16_bf16 v[16:31], v[76:79], v[64:67], v[16:31]
    ds_read_b64_tr_b16 v[92:93], v108 offset:3136
    ds_read_b64_tr_b16 v[94:95], v108 offset:3904
    ds_read_b64_tr_b16 v[96:97], v108 offset:3200
    v_mfma_f32_32x32x16_bf16 v[32:47], v[80:83], v[64:67], v[32:47]
    ds_read_b64_tr_b16 v[98:99], v108 offset:3968
    s_waitcnt lgkmcnt(0)
    v_mfma_f32_32x32x16_bf16 v[0:15], v[88:91], v[68:71], v[0:15]
    ds_read_b128 v[64:67], v106 offset:0
    ds_read_b64_tr_b16 v[72:73], v108 offset:6144
    ds_read_b64_tr_b16 v[74:75], v108 offset:6912
    v_mfma_f32_32x32x16_bf16 v[16:31], v[92:95], v[68:71], v[16:31]
    ds_read_b64_tr_b16 v[76:77], v108 offset:6208
    ds_read_b64_tr_b16 v[78:79], v108 offset:6976
    ds_read_b64_tr_b16 v[80:81], v108 offset:6272
    v_mfma_f32_32x32x16_bf16 v[32:47], v[96:99], v[68:71], v[32:47]
    ds_read_b64_tr_b16 v[82:83], v108 offset:7040
    s_waitcnt lgkmcnt(0)
    v_mfma_f32_32x32x16_bf16 v[0:15], v[72:75], v[64:67], v[0:15]
    ds_read_b128 v[68:71], v107 offset:0
    ds_read_b64_tr_b16 v[88:89], v108 offset:9216
    ds_read_b64_tr_b16 v[90:91], v108 offset:9984
    v_mfma_f32_32x32x16_bf16 v[16:31], v[76:79], v[64:67], v[16:31]
    ds_read_b64_tr_b16 v[92:93], v108 offset:9280
    ds_read_b64_tr_b16 v[94:95], v108 offset:10048
    ds_read_b64_tr_b16 v[96:97], v108 offset:9344
    v_mfma_f32_32x32x16_bf16 v[32:47], v[80:83], v[64:67], v[32:47]
    ds_read_b64_tr_b16 v[98:99], v108 offset:10112
    s_waitcnt lgkmcnt(0)
    v_mfma_f32_32x32x16_bf16 v[0:15], v[88:91], v[68:71], v[0:15]
    v_mfma_f32_32x32x16_bf16 v[16:31], v[92:95], v[68:71], v[16:31]
    v_mfma_f32_32x32x16_bf16 v[32:47], v[96:99], v[68:71], v[32:47]
    s_barrier
    ds_read_b128 v[64:67], v104 offset:16384
    ds_read_b64_tr_b16 v[72:73], v108 offset:12288
    ds_read_b64_tr_b16 v[74:75], v108 offset:13056
    ds_read_b64_tr_b16 v[76:77], v108 offset:12352
    ds_read_b64_tr_b16 v[78:79], v108 offset:13120
    ds_read_b64_tr_b16 v[80:81], v108 offset:12416
    ds_read_b64_tr_b16 v[82:83], v108 offset:13184
    s_waitcnt lgkmcnt(0)
    v_mfma_f32_32x32x16_bf16 v[0:15], v[72:75], v[64:67], v[0:15]
    ds_read_b128 v[68:71], v105 offset:16384
    ds_read_b64_tr_b16 v[88:89], v108 offset:15360
    ds_read_b64_tr_b16 v[90:91], v108 offset:16128
    v_mfma_f32_32x32x16_bf16 v[16:31], v[76:79], v[64:67], v[16:31]
    ds_read_b64_tr_b16 v[92:93], v108 offset:15424
    ds_read_b64_tr_b16 v[94:95], v108 offset:16192
    ds_read_b64_tr_b16 v[96:97], v108 offset:15488
    v_mfma_f32_32x32x16_bf16 v[32:47], v[80:83], v[64:67], v[32:47]
    ds_read_b64_tr_b16 v[98:99], v108 offset:16256
    s_waitcnt lgkmcnt(0)
    v_mfma_f32_32x32x16_bf16 v[0:15], v[88:91], v[68:71], v[0:15]
    ds_read_b128 v[64:67], v106 offset:16384
    ds_read_b64_tr_b16 v[72:73], v108 offset:18432
    ds_read_b64_tr_b16 v[74:75], v108 offset:19200
    v_mfma_f32_32x32x16_bf16 v[16:31], v[92:95], v[68:71], v[16:31]
    ds_read_b64_tr_b16 v[76:77], v108 offset:18496
    ds_read_b64_tr_b16 v[78:79], v108 offset:19264
    ds_read_b64_tr_b16 v[80:81], v108 offset:18560
    v_mfma_f32_32x32x16_bf16 v[32:47], v[96:99], v[68:71], v[32:47]
    ds_read_b64_tr_b16 v[82:83], v108 offset:19328
    s_waitcnt lgkmcnt(0)
    v_mfma_f32_32x32x16_bf16 v[0:15], v[72:75], v[64:67], v[0:15]
    ds_read_b128 v[68:71], v107 offset:16384
    ds_read_b64_tr_b16 v[88:89], v108 offset:21504
    ds_read_b64_tr_b16 v[90:91], v108 offset:22272
    v_mfma_f32_32x32x16_bf16 v[16:31], v[76:79], v[64:67], v[16:31]
    ds_read_b64_tr_b16 v[92:93], v108 offset:21568
    ds_read_b64_tr_b16 v[94:95], v108 offset:22336
    ds_read_b64_tr_b16 v[96:97], v108 offset:21632
    v_mfma_f32_32x32x16_bf16 v[32:47], v[80:83], v[64:67], v[32:47]
    ds_read_b64_tr_b16 v[98:99], v108 offset:22400
    s_waitcnt lgkmcnt(0)
    v_mfma_f32_32x32x16_bf16 v[0:15], v[88:91], v[68:71], v[0:15]
    ds_read_b128 v[64:67], v104 offset:32768
    ds_read_b64_tr_b16 v[72:73], v108 offset:24576
    ds_read_b64_tr_b16 v[74:75], v108 offset:25344
    v_mfma_f32_32x32x16_bf16 v[16:31], v[92:95], v[68:71], v[16:31]
    ds_read_b64_tr_b16 v[76:77], v108 offset:24640
    ds_read_b64_tr_b16 v[78:79], v108 offset:25408
    ds_read_b64_tr_b16 v[80:81], v108 offset:24704
    v_mfma_f32_32x32x16_bf16 v[32:47], v[96:99], v[68:71], v[32:47]
    ds_read_b64_tr_b16 v[82:83], v108 offset:25472
    s_barrier
    s_waitcnt lgkmcnt(0)
    v_mfma_f32_32x32x16_bf16 v[0:15], v[72:75], v[64:67], v[0:15]
    ds_read_b128 v[68:71], v105 offset:32768
    ds_read_b64_tr_b16 v[88:89], v108 offset:27648
    ds_read_b64_tr_b16 v[90:91], v108 offset:28416
    v_mfma_f32_32x32x16_bf16 v[16:31], v[76:79], v[64:67], v[16:31]
    ds_read_b64_tr_b16 v[92:93], v108 offset:27712
    ds_read_b64_tr_b16 v[94:95], v108 offset:28480
    ds_read_b64_tr_b16 v[96:97], v108 offset:27776
    v_mfma_f32_32x32x16_bf16 v[32:47], v[80:83], v[64:67], v[32:47]
    ds_read_b64_tr_b16 v[98:99], v108 offset:28544
    s_waitcnt lgkmcnt(0)
    v_mfma_f32_32x32x16_bf16 v[0:15], v[88:91], v[68:71], v[0:15]
    ds_read_b128 v[64:67], v106 offset:32768
    ds_read_b64_tr_b16 v[72:73], v108 offset:30720
    ds_read_b64_tr_b16 v[74:75], v108 offset:31488
    v_mfma_f32_32x32x16_bf16 v[16:31], v[92:95], v[68:71], v[16:31]
    ds_read_b64_tr_b16 v[76:77], v108 offset:30784
    ds_read_b64_tr_b16 v[78:79], v108 offset:31552
    ds_read_b64_tr_b16 v[80:81], v108 offset:30848
    v_mfma_f32_32x32x16_bf16 v[32:47], v[96:99], v[68:71], v[32:47]
    ds_read_b64_tr_b16 v[82:83], v108 offset:31616
    s_waitcnt lgkmcnt(0)
    v_mfma_f32_32x32x16_bf16 v[0:15], v[72:75], v[64:67], v[0:15]
    ds_read_b128 v[68:71], v107 offset:32768
    ds_read_b64_tr_b16 v[88:89], v108 offset:33792
    ds_read_b64_tr_b16 v[90:91], v108 offset:34560
    v_mfma_f32_32x32x16_bf16 v[16:31], v[76:79], v[64:67], v[16:31]
    ds_read_b64_tr_b16 v[92:93], v108 offset:33856
    ds_read_b64_tr_b16 v[94:95], v108 offset:34624
    ds_read_b64_tr_b16 v[96:97], v108 offset:33920
    v_mfma_f32_32x32x16_bf16 v[32:47], v[80:83], v[64:67], v[32:47]
    ds_read_b64_tr_b16 v[98:99], v108 offset:34688
    s_waitcnt lgkmcnt(0)
    v_mfma_f32_32x32x16_bf16 v[0:15], v[88:91], v[68:71], v[0:15]
    ds_read_b128 v[64:67], v104 offset:49152
    ds_read_b64_tr_b16 v[72:73], v108 offset:36864
    ds_read_b64_tr_b16 v[74:75], v108 offset:37632
    v_mfma_f32_32x32x16_bf16 v[16:31], v[92:95], v[68:71], v[16:31]
    ds_read_b64_tr_b16 v[76:77], v108 offset:36928
    ds_read_b64_tr_b16 v[78:79], v108 offset:37696
    ds_read_b64_tr_b16 v[80:81], v108 offset:36992
    v_mfma_f32_32x32x16_bf16 v[32:47], v[96:99], v[68:71], v[32:47]
    ds_read_b64_tr_b16 v[82:83], v108 offset:37760
    s_barrier
    s_waitcnt lgkmcnt(0)
    v_mfma_f32_32x32x16_bf16 v[0:15], v[72:75], v[64:67], v[0:15]
    ds_read_b128 v[68:71], v105 offset:49152
    ds_read_b64_tr_b16 v[88:89], v108 offset:0
    ds_read_b64_tr_b16 v[90:91], v108 offset:768
    v_mfma_f32_32x32x16_bf16 v[16:31], v[76:79], v[64:67], v[16:31]
    ds_read_b64_tr_b16 v[92:93], v108 offset:64
    ds_read_b64_tr_b16 v[94:95], v108 offset:832
    ds_read_b64_tr_b16 v[96:97], v108 offset:128
    v_mfma_f32_32x32x16_bf16 v[32:47], v[80:83], v[64:67], v[32:47]
    ds_read_b64_tr_b16 v[98:99], v108 offset:896
    s_waitcnt lgkmcnt(0)
    v_mfma_f32_32x32x16_bf16 v[0:15], v[88:91], v[68:71], v[0:15]
    ds_read_b128 v[64:67], v106 offset:49152
    ds_read_b64_tr_b16 v[72:73], v108 offset:3072
    ds_read_b64_tr_b16 v[74:75], v108 offset:3840
    v_mfma_f32_32x32x16_bf16 v[16:31], v[92:95], v[68:71], v[16:31]
    ds_read_b64_tr_b16 v[76:77], v108 offset:3136
    ds_read_b64_tr_b16 v[78:79], v108 offset:3904
    ds_read_b64_tr_b16 v[80:81], v108 offset:3200
    v_mfma_f32_32x32x16_bf16 v[32:47], v[96:99], v[68:71], v[32:47]
    ds_read_b64_tr_b16 v[82:83], v108 offset:3968
    s_waitcnt lgkmcnt(0)
    v_mfma_f32_32x32x16_bf16 v[0:15], v[72:75], v[64:67], v[0:15]
    ds_read_b128 v[68:71], v107 offset:49152
    ds_read_b64_tr_b16 v[88:89], v108 offset:6144
    ds_read_b64_tr_b16 v[90:91], v108 offset:6912
    v_mfma_f32_32x32x16_bf16 v[16:31], v[76:79], v[64:67], v[16:31]
    ds_read_b64_tr_b16 v[92:93], v108 offset:6208
    ds_read_b64_tr_b16 v[94:95], v108 offset:6976
    ds_read_b64_tr_b16 v[96:97], v108 offset:6272
    v_mfma_f32_32x32x16_bf16 v[32:47], v[80:83], v[64:67], v[32:47]
    ds_read_b64_tr_b16 v[98:99], v108 offset:7040
    s_waitcnt lgkmcnt(0)
    v_mfma_f32_32x32x16_bf16 v[0:15], v[88:91], v[68:71], v[0:15]
    ds_read_b128 v[64:67], v104 offset:0
    ds_read_b64_tr_b16 v[72:73], v108 offset:9216
    ds_read_b64_tr_b16 v[74:75], v108 offset:9984
    v_mfma_f32_32x32x16_bf16 v[16:31], v[92:95], v[68:71], v[16:31]
    ds_read_b64_tr_b16 v[76:77], v108 offset:9280
    ds_read_b64_tr_b16 v[78:79], v108 offset:10048
    ds_read_b64_tr_b16 v[80:81], v108 offset:9344
    v_mfma_f32_32x32x16_bf16 v[32:47], v[96:99], v[68:71], v[32:47]
    ds_read_b64_tr_b16 v[82:83], v108 offset:10112
    s_barrier
    s_waitcnt lgkmcnt(0)
    v_mfma_f32_32x32x16_bf16 v[0:15], v[72:75], v[64:67], v[0:15]
    ds_read_b128 v[68:71], v105 offset:0
    ds_read_b64_tr_b16 v[88:89], v108 offset:12288
    ds_read_b64_tr_b16 v[90:91], v108 offset:13056
    v_mfma_f32_32x32x16_bf16 v[16:31], v[76:79], v[64:67], v[16:31]
    ds_read_b64_tr_b16 v[92:93], v108 offset:12352
    ds_read_b64_tr_b16 v[94:95], v108 offset:13120
    ds_read_b64_tr_b16 v[96:97], v108 offset:12416
    v_mfma_f32_32x32x16_bf16 v[32:47], v[80:83], v[64:67], v[32:47]
    ds_read_b64_tr_b16 v[98:99], v108 offset:13184
    s_waitcnt lgkmcnt(0)
    v_mfma_f32_32x32x16_bf16 v[0:15], v[88:91], v[68:71], v[0:15]
    ds_read_b128 v[64:67], v106 offset:0
    ds_read_b64_tr_b16 v[72:73], v108 offset:15360
    ds_read_b64_tr_b16 v[74:75], v108 offset:16128
    v_mfma_f32_32x32x16_bf16 v[16:31], v[92:95], v[68:71], v[16:31]
    ds_read_b64_tr_b16 v[76:77], v108 offset:15424
    ds_read_b64_tr_b16 v[78:79], v108 offset:16192
    ds_read_b64_tr_b16 v[80:81], v108 offset:15488
    v_mfma_f32_32x32x16_bf16 v[32:47], v[96:99], v[68:71], v[32:47]
    ds_read_b64_tr_b16 v[82:83], v108 offset:16256
    s_waitcnt lgkmcnt(0)
    v_mfma_f32_32x32x16_bf16 v[0:15], v[72:75], v[64:67], v[0:15]
    ds_read_b128 v[68:71], v107 offset:0
    ds_read_b64_tr_b16 v[88:89], v108 offset:18432
    ds_read_b64_tr_b16 v[90:91], v108 offset:19200
    v_mfma_f32_32x32x16_bf16 v[16:31], v[76:79], v[64:67], v[16:31]
    ds_read_b64_tr_b16 v[92:93], v108 offset:18496
    ds_read_b64_tr_b16 v[94:95], v108 offset:19264
    ds_read_b64_tr_b16 v[96:97], v108 offset:18560
    v_mfma_f32_32x32x16_bf16 v[32:47], v[80:83], v[64:67], v[32:47]
    ds_read_b64_tr_b16 v[98:99], v108 offset:19328
    s_waitcnt lgkmcnt(0)
    v_mfma_f32_32x32x16_bf16 v[0:15], v[88:91], v[68:71], v[0:15]
    ds_read_b128 v[64:67], v104 offset:16384
    ds_read_b64_tr_b16 v[72:73], v108 offset:21504
    ds_read_b64_tr_b16 v[74:75], v108 offset:22272
    v_mfma_f32_32x32x16_bf16 v[16:31], v[92:95], v[68:71], v[16:31]
    ds_read_b64_tr_b16 v[76:77], v108 offset:21568
    ds_read_b64_tr_b16 v[78:79], v108 offset:22336
    ds_read_b64_tr_b16 v[80:81], v108 offset:21632
    v_mfma_f32_32x32x16_bf16 v[32:47], v[96:99], v[68:71], v[32:47]
    ds_read_b64_tr_b16 v[82:83], v108 offset:22400
    s_barrier
    s_waitcnt lgkmcnt(0)
    v_mfma_f32_32x32x16_bf16 v[0:15], v[72:75], v[64:67], v[0:15]
    ds_read_b128 v[68:71], v105 offset:16384
    ds_read_b64_tr_b16 v[88:89], v108 offset:24576
    ds_read_b64_tr_b16 v[90:91], v108 offset:25344
    v_mfma_f32_32x32x16_bf16 v[16:31], v[76:79], v[64:67], v[16:31]
    ds_read_b64_tr_b16 v[92:93], v108 offset:24640
    ds_read_b64_tr_b16 v[94:95], v108 offset:25408
    ds_read_b64_tr_b16 v[96:97], v108 offset:24704
    v_mfma_f32_32x32x16_bf16 v[32:47], v[80:83], v[64:67], v[32:47]
    ds_read_b64_tr_b16 v[98:99], v108 offset:25472
    s_waitcnt lgkmcnt(0)
    v_mfma_f32_32x32x16_bf16 v[0:15], v[88:91], v[68:71], v[0:15]
    ds_read_b128 v[64:67], v106 offset:16384
    ds_read_b64_tr_b16 v[72:73], v108 offset:27648
    ds_read_b64_tr_b16 v[74:75], v108 offset:28416
    v_mfma_f32_32x32x16_bf16 v[16:31], v[92:95], v[68:71], v[16:31]
    ds_read_b64_tr_b16 v[76:77], v108 offset:27712
    ds_read_b64_tr_b16 v[78:79], v108 offset:28480
    ds_read_b64_tr_b16 v[80:81], v108 offset:27776
    v_mfma_f32_32x32x16_bf16 v[32:47], v[96:99], v[68:71], v[32:47]
    ds_read_b64_tr_b16 v[82:83], v108 offset:28544
    s_waitcnt lgkmcnt(0)
    v_mfma_f32_32x32x16_bf16 v[0:15], v[72:75], v[64:67], v[0:15]
    ds_read_b128 v[68:71], v107 offset:16384
    ds_read_b64_tr_b16 v[88:89], v108 offset:30720
    ds_read_b64_tr_b16 v[90:91], v108 offset:31488
    v_mfma_f32_32x32x16_bf16 v[16:31], v[76:79], v[64:67], v[16:31]
    ds_read_b64_tr_b16 v[92:93], v108 offset:30784
    ds_read_b64_tr_b16 v[94:95], v108 offset:31552
    ds_read_b64_tr_b16 v[96:97], v108 offset:30848
    v_mfma_f32_32x32x16_bf16 v[32:47], v[80:83], v[64:67], v[32:47]
    ds_read_b64_tr_b16 v[98:99], v108 offset:31616
    s_waitcnt lgkmcnt(0)
    v_mfma_f32_32x32x16_bf16 v[0:15], v[88:91], v[68:71], v[0:15]
    ds_read_b128 v[64:67], v104 offset:32768
    ds_read_b64_tr_b16 v[72:73], v108 offset:33792
    ds_read_b64_tr_b16 v[74:75], v108 offset:34560
    v_mfma_f32_32x32x16_bf16 v[16:31], v[92:95], v[68:71], v[16:31]
    ds_read_b64_tr_b16 v[76:77], v108 offset:33856
    ds_read_b64_tr_b16 v[78:79], v108 offset:34624
    ds_read_b64_tr_b16 v[80:81], v108 offset:33920
    v_mfma_f32_32x32x16_bf16 v[32:47], v[96:99], v[68:71], v[32:47]
    ds_read_b64_tr_b16 v[82:83], v108 offset:34688
    s_barrier
    s_waitcnt lgkmcnt(0)
    v_mfma_f32_32x32x16_bf16 v[0:15], v[72:75], v[64:67], v[0:15]
    ds_read_b128 v[68:71], v105 offset:32768
    ds_read_b64_tr_b16 v[88:89], v108 offset:36864
    ds_read_b64_tr_b16 v[90:91], v108 offset:37632
    v_mfma_f32_32x32x16_bf16 v[16:31], v[76:79], v[64:67], v[16:31]
    ds_read_b64_tr_b16 v[92:93], v108 offset:36928
    ds_read_b64_tr_b16 v[94:95], v108 offset:37696
    ds_read_b64_tr_b16 v[96:97], v108 offset:36992
    v_mfma_f32_32x32x16_bf16 v[32:47], v[80:83], v[64:67], v[32:47]
    ds_read_b64_tr_b16 v[98:99], v108 offset:37760
    s_waitcnt lgkmcnt(0)
    v_mfma_f32_32x32x16_bf16 v[0:15], v[88:91], v[68:71], v[0:15]
    ds_read_b128 v[64:67], v106 offset:32768
    ds_read_b64_tr_b16 v[72:73], v108 offset:0
    ds_read_b64_tr_b16 v[74:75], v108 offset:768
    v_mfma_f32_32x32x16_bf16 v[16:31], v[92:95], v[68:71], v[16:31]
    ds_read_b64_tr_b16 v[76:77], v108 offset:64
    ds_read_b64_tr_b16 v[78:79], v108 offset:832
    ds_read_b64_tr_b16 v[80:81], v108 offset:128
    v_mfma_f32_32x32x16_bf16 v[32:47], v[96:99], v[68:71], v[32:47]
    ds_read_b64_tr_b16 v[82:83], v108 offset:896
    s_waitcnt lgkmcnt(0)
    v_mfma_f32_32x32x16_bf16 v[0:15], v[72:75], v[64:67], v[0:15]
    ds_read_b128 v[68:71], v107 offset:32768
    ds_read_b64_tr_b16 v[88:89], v108 offset:3072
    ds_read_b64_tr_b16 v[90:91], v108 offset:3840
    v_mfma_f32_32x32x16_bf16 v[16:31], v[76:79], v[64:67], v[16:31]
    ds_read_b64_tr_b16 v[92:93], v108 offset:3136
    ds_read_b64_tr_b16 v[94:95], v108 offset:3904
    ds_read_b64_tr_b16 v[96:97], v108 offset:3200
    v_mfma_f32_32x32x16_bf16 v[32:47], v[80:83], v[64:67], v[32:47]
    ds_read_b64_tr_b16 v[98:99], v108 offset:3968
    s_waitcnt lgkmcnt(0)
    v_mfma_f32_32x32x16_bf16 v[0:15], v[88:91], v[68:71], v[0:15]
    ds_read_b128 v[64:67], v104 offset:49152
    ds_read_b64_tr_b16 v[72:73], v108 offset:6144
    ds_read_b64_tr_b16 v[74:75], v108 offset:6912
    v_mfma_f32_32x32x16_bf16 v[16:31], v[92:95], v[68:71], v[16:31]
    ds_read_b64_tr_b16 v[76:77], v108 offset:6208
    ds_read_b64_tr_b16 v[78:79], v108 offset:6976
    ds_read_b64_tr_b16 v[80:81], v108 offset:6272
    v_mfma_f32_32x32x16_bf16 v[32:47], v[96:99], v[68:71], v[32:47]
    ds_read_b64_tr_b16 v[82:83], v108 offset:7040
    s_barrier
    s_waitcnt lgkmcnt(0)
    v_mfma_f32_32x32x16_bf16 v[0:15], v[72:75], v[64:67], v[0:15]
    ds_read_b128 v[68:71], v105 offset:49152
    ds_read_b64_tr_b16 v[88:89], v108 offset:9216
    ds_read_b64_tr_b16 v[90:91], v108 offset:9984
    v_mfma_f32_32x32x16_bf16 v[16:31], v[76:79], v[64:67], v[16:31]
    ds_read_b64_tr_b16 v[92:93], v108 offset:9280
    ds_read_b64_tr_b16 v[94:95], v108 offset:10048
    ds_read_b64_tr_b16 v[96:97], v108 offset:9344
    v_mfma_f32_32x32x16_bf16 v[32:47], v[80:83], v[64:67], v[32:47]
    ds_read_b64_tr_b16 v[98:99], v108 offset:10112
    s_waitcnt lgkmcnt(0)
    v_mfma_f32_32x32x16_bf16 v[0:15], v[88:91], v[68:71], v[0:15]
    ds_read_b128 v[64:67], v106 offset:49152
    ds_read_b64_tr_b16 v[72:73], v108 offset:12288
    ds_read_b64_tr_b16 v[74:75], v108 offset:13056
    v_mfma_f32_32x32x16_bf16 v[16:31], v[92:95], v[68:71], v[16:31]
    ds_read_b64_tr_b16 v[76:77], v108 offset:12352
    ds_read_b64_tr_b16 v[78:79], v108 offset:13120
    ds_read_b64_tr_b16 v[80:81], v108 offset:12416
    v_mfma_f32_32x32x16_bf16 v[32:47], v[96:99], v[68:71], v[32:47]
    ds_read_b64_tr_b16 v[82:83], v108 offset:13184
    s_waitcnt lgkmcnt(0)
    v_mfma_f32_32x32x16_bf16 v[0:15], v[72:75], v[64:67], v[0:15]
    ds_read_b128 v[68:71], v107 offset:49152
    ds_read_b64_tr_b16 v[88:89], v108 offset:15360
    ds_read_b64_tr_b16 v[90:91], v108 offset:16128
    v_mfma_f32_32x32x16_bf16 v[16:31], v[76:79], v[64:67], v[16:31]
    ds_read_b64_tr_b16 v[92:93], v108 offset:15424
    ds_read_b64_tr_b16 v[94:95], v108 offset:16192
    ds_read_b64_tr_b16 v[96:97], v108 offset:15488
    v_mfma_f32_32x32x16_bf16 v[32:47], v[80:83], v[64:67], v[32:47]
    ds_read_b64_tr_b16 v[98:99], v108 offset:16256
    s_waitcnt lgkmcnt(0)
    v_mfma_f32_32x32x16_bf16 v[0:15], v[88:91], v[68:71], v[0:15]
    ds_read_b128 v[64:67], v104 offset:0
    ds_read_b64_tr_b16 v[72:73], v108 offset:18432
    ds_read_b64_tr_b16 v[74:75], v108 offset:19200
    v_mfma_f32_32x32x16_bf16 v[16:31], v[92:95], v[68:71], v[16:31]
    ds_read_b64_tr_b16 v[76:77], v108 offset:18496
    ds_read_b64_tr_b16 v[78:79], v108 offset:19264
    ds_read_b64_tr_b16 v[80:81], v108 offset:18560
    v_mfma_f32_32x32x16_bf16 v[32:47], v[96:99], v[68:71], v[32:47]
    ds_read_b64_tr_b16 v[82:83], v108 offset:19328
    s_barrier
    s_waitcnt lgkmcnt(0)
    v_mfma_f32_32x32x16_bf16 v[0:15], v[72:75], v[64:67], v[0:15]
    ds_read_b128 v[68:71], v105 offset:0
    ds_read_b64_tr_b16 v[88:89], v108 offset:21504
    ds_read_b64_tr_b16 v[90:91], v108 offset:22272
    v_mfma_f32_32x32x16_bf16 v[16:31], v[76:79], v[64:67], v[16:31]
    ds_read_b64_tr_b16 v[92:93], v108 offset:21568
    ds_read_b64_tr_b16 v[94:95], v108 offset:22336
    ds_read_b64_tr_b16 v[96:97], v108 offset:21632
    v_mfma_f32_32x32x16_bf16 v[32:47], v[80:83], v[64:67], v[32:47]
    ds_read_b64_tr_b16 v[98:99], v108 offset:22400
    s_waitcnt lgkmcnt(0)
    v_mfma_f32_32x32x16_bf16 v[0:15], v[88:91], v[68:71], v[0:15]
    ds_read_b128 v[64:67], v106 offset:0
    ds_read_b64_tr_b16 v[72:73], v108 offset:24576
    ds_read_b64_tr_b16 v[74:75], v108 offset:25344
    v_mfma_f32_32x32x16_bf16 v[16:31], v[92:95], v[68:71], v[16:31]
    ds_read_b64_tr_b16 v[76:77], v108 offset:24640
    ds_read_b64_tr_b16 v[78:79], v108 offset:25408
    ds_read_b64_tr_b16 v[80:81], v108 offset:24704
    v_mfma_f32_32x32x16_bf16 v[32:47], v[96:99], v[68:71], v[32:47]
    ds_read_b64_tr_b16 v[82:83], v108 offset:25472
    s_waitcnt lgkmcnt(0)
    v_mfma_f32_32x32x16_bf16 v[0:15], v[72:75], v[64:67], v[0:15]
    ds_read_b128 v[68:71], v107 offset:0
    ds_read_b64_tr_b16 v[88:89], v108 offset:27648
    ds_read_b64_tr_b16 v[90:91], v108 offset:28416
    v_mfma_f32_32x32x16_bf16 v[16:31], v[76:79], v[64:67], v[16:31]
    ds_read_b64_tr_b16 v[92:93], v108 offset:27712
    ds_read_b64_tr_b16 v[94:95], v108 offset:28480
    ds_read_b64_tr_b16 v[96:97], v108 offset:27776
    v_mfma_f32_32x32x16_bf16 v[32:47], v[80:83], v[64:67], v[32:47]
    ds_read_b64_tr_b16 v[98:99], v108 offset:28544
    s_waitcnt lgkmcnt(0)
    v_mfma_f32_32x32x16_bf16 v[0:15], v[88:91], v[68:71], v[0:15]
    ds_read_b128 v[64:67], v104 offset:16384
    ds_read_b64_tr_b16 v[72:73], v108 offset:30720
    ds_read_b64_tr_b16 v[74:75], v108 offset:31488
    v_mfma_f32_32x32x16_bf16 v[16:31], v[92:95], v[68:71], v[16:31]
    ds_read_b64_tr_b16 v[76:77], v108 offset:30784
    ds_read_b64_tr_b16 v[78:79], v108 offset:31552
    ds_read_b64_tr_b16 v[80:81], v108 offset:30848
    v_mfma_f32_32x32x16_bf16 v[32:47], v[96:99], v[68:71], v[32:47]
    ds_read_b64_tr_b16 v[82:83], v108 offset:31616
    s_barrier
    s_waitcnt lgkmcnt(0)
    v_mfma_f32_32x32x16_bf16 v[0:15], v[72:75], v[64:67], v[0:15]
    ds_read_b128 v[68:71], v105 offset:16384
    ds_read_b64_tr_b16 v[88:89], v108 offset:33792
    ds_read_b64_tr_b16 v[90:91], v108 offset:34560
    v_mfma_f32_32x32x16_bf16 v[16:31], v[76:79], v[64:67], v[16:31]
    ds_read_b64_tr_b16 v[92:93], v108 offset:33856
    ds_read_b64_tr_b16 v[94:95], v108 offset:34624
    ds_read_b64_tr_b16 v[96:97], v108 offset:33920
    v_mfma_f32_32x32x16_bf16 v[32:47], v[80:83], v[64:67], v[32:47]
    ds_read_b64_tr_b16 v[98:99], v108 offset:34688
    s_waitcnt lgkmcnt(0)
    v_mfma_f32_32x32x16_bf16 v[0:15], v[88:91], v[68:71], v[0:15]
    ds_read_b128 v[64:67], v106 offset:16384
    ds_read_b64_tr_b16 v[72:73], v108 offset:36864
    ds_read_b64_tr_b16 v[74:75], v108 offset:37632
    v_mfma_f32_32x32x16_bf16 v[16:31], v[92:95], v[68:71], v[16:31]
    ds_read_b64_tr_b16 v[76:77], v108 offset:36928
    ds_read_b64_tr_b16 v[78:79], v108 offset:37696
    ds_read_b64_tr_b16 v[80:81], v108 offset:36992
    v_mfma_f32_32x32x16_bf16 v[32:47], v[96:99], v[68:71], v[32:47]
    ds_read_b64_tr_b16 v[82:83], v108 offset:37760
    s_waitcnt lgkmcnt(0)
    v_mfma_f32_32x32x16_bf16 v[0:15], v[72:75], v[64:67], v[0:15]
    ds_read_b128 v[68:71], v107 offset:16384
    ds_read_b64_tr_b16 v[88:89], v108 offset:0
    ds_read_b64_tr_b16 v[90:91], v108 offset:768
    v_mfma_f32_32x32x16_bf16 v[16:31], v[76:79], v[64:67], v[16:31]
    ds_read_b64_tr_b16 v[92:93], v108 offset:64
    ds_read_b64_tr_b16 v[94:95], v108 offset:832
    ds_read_b64_tr_b16 v[96:97], v108 offset:128
    v_mfma_f32_32x32x16_bf16 v[32:47], v[80:83], v[64:67], v[32:47]
    ds_read_b64_tr_b16 v[98:99], v108 offset:896
    s_waitcnt lgkmcnt(0)
    v_mfma_f32_32x32x16_bf16 v[0:15], v[88:91], v[68:71], v[0:15]
    v_mfma_f32_32x32x16_bf16 v[16:31], v[92:95], v[68:71], v[16:31]
    v_mfma_f32_32x32x16_bf16 v[32:47], v[96:99], v[68:71], v[32:47]
    s_nop 15
    v_mov_b32 v104, 0x3fb8aa3b
    v_mov_b32 v105, 0x3fb8aa3b
    v_lshlrev_b32 v124, 15, v118
    v_lshl_add_u32 v124, v117, 4, v124
    s_lshl_b32 s36, s25, 7
    s_lshl_b32 s37, s27, 5
    s_add_u32 s36, s36, s37
    s_lshl_b32 s36, s36, 4
    s_mul_i32 s37, s26, 393216
    s_add_u32 s36, s36, s37
    s_add_u32 s36, s36, 7864320
    v_mov_b32 v106, -2.0
    v_mov_b32 v107, -2.0
    v_pk_mul_f32 v[72:73], v[0:1], v[104:105]
    v_pk_mul_f32 v[74:75], v[2:3], v[104:105]
    v_pk_mul_f32 v[76:77], v[4:5], v[104:105]
    v_pk_mul_f32 v[78:79], v[6:7], v[104:105]
    v_exp_f32 v72, v72
    v_exp_f32 v73, v73
    v_exp_f32 v74, v74
    v_exp_f32 v75, v75
    v_exp_f32 v76, v76
    v_exp_f32 v77, v77
    v_exp_f32 v78, v78
    v_exp_f32 v79, v79
    v_pk_add_f32 v[80:81], v[72:73], 2.0 op_sel_hi:[1,0]
    v_pk_add_f32 v[82:83], v[74:75], 2.0 op_sel_hi:[1,0]
    v_pk_add_f32 v[84:85], v[76:77], 2.0 op_sel_hi:[1,0]
    v_pk_add_f32 v[86:87], v[78:79], 2.0 op_sel_hi:[1,0]
    v_pk_fma_f32 v[80:81], v[72:73], v[80:81], 2.0 op_sel_hi:[1,1,0]
    v_pk_fma_f32 v[82:83], v[74:75], v[82:83], 2.0 op_sel_hi:[1,1,0]
    v_pk_fma_f32 v[84:85], v[76:77], v[84:85], 2.0 op_sel_hi:[1,1,0]
    v_pk_fma_f32 v[86:87], v[78:79], v[86:87], 2.0 op_sel_hi:[1,1,0]
    v_rcp_f32 v80, v80
    v_rcp_f32 v81, v81
    v_rcp_f32 v82, v82
    v_rcp_f32 v83, v83
    v_rcp_f32 v84, v84
    v_rcp_f32 v85, v85
    v_rcp_f32 v86, v86
    v_rcp_f32 v87, v87
    s_nop 0
    v_pk_fma_f32 v[80:81], v[80:81], v[106:107], 1.0 op_sel_hi:[1,1,0]
    v_pk_fma_f32 v[82:83], v[82:83], v[106:107], 1.0 op_sel_hi:[1,1,0]
    v_pk_fma_f32 v[84:85], v[84:85], v[106:107], 1.0 op_sel_hi:[1,1,0]
    v_pk_fma_f32 v[86:87], v[86:87], v[106:107], 1.0 op_sel_hi:[1,1,0]
    v_pk_mul_f32 v[0:1], v[0:1], v[80:81]
    v_pk_mul_f32 v[2:3], v[2:3], v[82:83]
    v_pk_mul_f32 v[4:5], v[4:5], v[84:85]
    v_pk_mul_f32 v[6:7], v[6:7], v[86:87]
    v_pk_mul_f32 v[72:73], v[8:9], v[104:105]
    v_pk_mul_f32 v[74:75], v[10:11], v[104:105]
    v_pk_mul_f32 v[76:77], v[12:13], v[104:105]
    v_pk_mul_f32 v[78:79], v[14:15], v[104:105]
    v_exp_f32 v72, v72
    v_exp_f32 v73, v73
    v_exp_f32 v74, v74
    v_exp_f32 v75, v75
    v_exp_f32 v76, v76
    v_exp_f32 v77, v77
    v_exp_f32 v78, v78
    v_exp_f32 v79, v79
    v_pk_add_f32 v[80:81], v[72:73], 2.0 op_sel_hi:[1,0]
    v_pk_add_f32 v[82:83], v[74:75], 2.0 op_sel_hi:[1,0]
    v_pk_add_f32 v[84:85], v[76:77], 2.0 op_sel_hi:[1,0]
    v_pk_add_f32 v[86:87], v[78:79], 2.0 op_sel_hi:[1,0]
    v_pk_fma_f32 v[80:81], v[72:73], v[80:81], 2.0 op_sel_hi:[1,1,0]
    v_pk_fma_f32 v[82:83], v[74:75], v[82:83], 2.0 op_sel_hi:[1,1,0]
    v_pk_fma_f32 v[84:85], v[76:77], v[84:85], 2.0 op_sel_hi:[1,1,0]
    v_pk_fma_f32 v[86:87], v[78:79], v[86:87], 2.0 op_sel_hi:[1,1,0]
    v_rcp_f32 v80, v80
    v_rcp_f32 v81, v81
    v_rcp_f32 v82, v82
    v_rcp_f32 v83, v83
    v_rcp_f32 v84, v84
    v_rcp_f32 v85, v85
    v_rcp_f32 v86, v86
    v_rcp_f32 v87, v87
    s_nop 0
    v_pk_fma_f32 v[80:81], v[80:81], v[106:107], 1.0 op_sel_hi:[1,1,0]
    v_pk_fma_f32 v[82:83], v[82:83], v[106:107], 1.0 op_sel_hi:[1,1,0]
    v_pk_fma_f32 v[84:85], v[84:85], v[106:107], 1.0 op_sel_hi:[1,1,0]
    v_pk_fma_f32 v[86:87], v[86:87], v[106:107], 1.0 op_sel_hi:[1,1,0]
    v_pk_mul_f32 v[8:9], v[8:9], v[80:81]
    v_pk_mul_f32 v[10:11], v[10:11], v[82:83]
    v_pk_mul_f32 v[12:13], v[12:13], v[84:85]
    v_pk_mul_f32 v[14:15], v[14:15], v[86:87]
    v_cvt_pk_bf16_f32 v64, v0, v1
    v_cvt_pk_bf16_f32 v65, v2, v3
    v_cvt_pk_bf16_f32 v66, v4, v5
    v_cvt_pk_bf16_f32 v67, v6, v7
    v_cvt_pk_bf16_f32 v68, v8, v9
    v_cvt_pk_bf16_f32 v69, v10, v11
    v_cvt_pk_bf16_f32 v70, v12, v13
    v_cvt_pk_bf16_f32 v71, v14, v15
    s_nop 1
    v_permlane32_swap_b32 v64, v66
    v_permlane32_swap_b32 v65, v67
    v_permlane32_swap_b32 v68, v70
    v_permlane32_swap_b32 v69, v71
    buffer_store_dwordx4 v[64:67], v124, s[4:7], s36 offen nt
    s_add_u32 s36, s36, 65536
    buffer_store_dwordx4 v[68:71], v124, s[4:7], s36 offen nt
    s_add_u32 s36, s36, 65536
    v_pk_mul_f32 v[72:73], v[16:17], v[104:105]
    v_pk_mul_f32 v[74:75], v[18:19], v[104:105]
    v_pk_mul_f32 v[76:77], v[20:21], v[104:105]
    v_pk_mul_f32 v[78:79], v[22:23], v[104:105]
    v_exp_f32 v72, v72
    v_exp_f32 v73, v73
    v_exp_f32 v74, v74
    v_exp_f32 v75, v75
    v_exp_f32 v76, v76
    v_exp_f32 v77, v77
    v_exp_f32 v78, v78
    v_exp_f32 v79, v79
    v_pk_add_f32 v[80:81], v[72:73], 2.0 op_sel_hi:[1,0]
    v_pk_add_f32 v[82:83], v[74:75], 2.0 op_sel_hi:[1,0]
    v_pk_add_f32 v[84:85], v[76:77], 2.0 op_sel_hi:[1,0]
    v_pk_add_f32 v[86:87], v[78:79], 2.0 op_sel_hi:[1,0]
    v_pk_fma_f32 v[80:81], v[72:73], v[80:81], 2.0 op_sel_hi:[1,1,0]
    v_pk_fma_f32 v[82:83], v[74:75], v[82:83], 2.0 op_sel_hi:[1,1,0]
    v_pk_fma_f32 v[84:85], v[76:77], v[84:85], 2.0 op_sel_hi:[1,1,0]
    v_pk_fma_f32 v[86:87], v[78:79], v[86:87], 2.0 op_sel_hi:[1,1,0]
    v_rcp_f32 v80, v80
    v_rcp_f32 v81, v81
    v_rcp_f32 v82, v82
    v_rcp_f32 v83, v83
    v_rcp_f32 v84, v84
    v_rcp_f32 v85, v85
    v_rcp_f32 v86, v86
    v_rcp_f32 v87, v87
    s_nop 0
    v_pk_fma_f32 v[80:81], v[80:81], v[106:107], 1.0 op_sel_hi:[1,1,0]
    v_pk_fma_f32 v[82:83], v[82:83], v[106:107], 1.0 op_sel_hi:[1,1,0]
    v_pk_fma_f32 v[84:85], v[84:85], v[106:107], 1.0 op_sel_hi:[1,1,0]
    v_pk_fma_f32 v[86:87], v[86:87], v[106:107], 1.0 op_sel_hi:[1,1,0]
    v_pk_mul_f32 v[16:17], v[16:17], v[80:81]
    v_pk_mul_f32 v[18:19], v[18:19], v[82:83]
    v_pk_mul_f32 v[20:21], v[20:21], v[84:85]
    v_pk_mul_f32 v[22:23], v[22:23], v[86:87]
    v_pk_mul_f32 v[72:73], v[24:25], v[104:105]
    v_pk_mul_f32 v[74:75], v[26:27], v[104:105]
    v_pk_mul_f32 v[76:77], v[28:29], v[104:105]
    v_pk_mul_f32 v[78:79], v[30:31], v[104:105]
    v_exp_f32 v72, v72
    v_exp_f32 v73, v73
    v_exp_f32 v74, v74
    v_exp_f32 v75, v75
    v_exp_f32 v76, v76
    v_exp_f32 v77, v77
    v_exp_f32 v78, v78
    v_exp_f32 v79, v79
    v_pk_add_f32 v[80:81], v[72:73], 2.0 op_sel_hi:[1,0]
    v_pk_add_f32 v[82:83], v[74:75], 2.0 op_sel_hi:[1,0]
    v_pk_add_f32 v[84:85], v[76:77], 2.0 op_sel_hi:[1,0]
    v_pk_add_f32 v[86:87], v[78:79], 2.0 op_sel_hi:[1,0]
    v_pk_fma_f32 v[80:81], v[72:73], v[80:81], 2.0 op_sel_hi:[1,1,0]
    v_pk_fma_f32 v[82:83], v[74:75], v[82:83], 2.0 op_sel_hi:[1,1,0]
    v_pk_fma_f32 v[84:85], v[76:77], v[84:85], 2.0 op_sel_hi:[1,1,0]
    v_pk_fma_f32 v[86:87], v[78:79], v[86:87], 2.0 op_sel_hi:[1,1,0]
    v_rcp_f32 v80, v80
    v_rcp_f32 v81, v81
    v_rcp_f32 v82, v82
    v_rcp_f32 v83, v83
    v_rcp_f32 v84, v84
    v_rcp_f32 v85, v85
    v_rcp_f32 v86, v86
    v_rcp_f32 v87, v87
    s_nop 0
    v_pk_fma_f32 v[80:81], v[80:81], v[106:107], 1.0 op_sel_hi:[1,1,0]
    v_pk_fma_f32 v[82:83], v[82:83], v[106:107], 1.0 op_sel_hi:[1,1,0]
    v_pk_fma_f32 v[84:85], v[84:85], v[106:107], 1.0 op_sel_hi:[1,1,0]
    v_pk_fma_f32 v[86:87], v[86:87], v[106:107], 1.0 op_sel_hi:[1,1,0]
    v_pk_mul_f32 v[24:25], v[24:25], v[80:81]
    v_pk_mul_f32 v[26:27], v[26:27], v[82:83]
    v_pk_mul_f32 v[28:29], v[28:29], v[84:85]
    v_pk_mul_f32 v[30:31], v[30:31], v[86:87]
    v_cvt_pk_bf16_f32 v96, v16, v17
    v_cvt_pk_bf16_f32 v97, v18, v19
    v_cvt_pk_bf16_f32 v98, v20, v21
    v_cvt_pk_bf16_f32 v99, v22, v23
    v_cvt_pk_bf16_f32 v100, v24, v25
    v_cvt_pk_bf16_f32 v101, v26, v27
    v_cvt_pk_bf16_f32 v102, v28, v29
    v_cvt_pk_bf16_f32 v103, v30, v31
    s_nop 1
    v_permlane32_swap_b32 v96, v98
    v_permlane32_swap_b32 v97, v99
    v_permlane32_swap_b32 v100, v102
    v_permlane32_swap_b32 v101, v103
    buffer_store_dwordx4 v[96:99], v124, s[4:7], s36 offen nt
    s_add_u32 s36, s36, 65536
    buffer_store_dwordx4 v[100:103], v124, s[4:7], s36 offen nt
    s_add_u32 s36, s36, 65536
    v_pk_mul_f32 v[72:73], v[32:33], v[104:105]
    v_pk_mul_f32 v[74:75], v[34:35], v[104:105]
    v_pk_mul_f32 v[76:77], v[36:37], v[104:105]
    v_pk_mul_f32 v[78:79], v[38:39], v[104:105]
    v_exp_f32 v72, v72
    v_exp_f32 v73, v73
    v_exp_f32 v74, v74
    v_exp_f32 v75, v75
    v_exp_f32 v76, v76
    v_exp_f32 v77, v77
    v_exp_f32 v78, v78
    v_exp_f32 v79, v79
    v_pk_add_f32 v[80:81], v[72:73], 2.0 op_sel_hi:[1,0]
    v_pk_add_f32 v[82:83], v[74:75], 2.0 op_sel_hi:[1,0]
    v_pk_add_f32 v[84:85], v[76:77], 2.0 op_sel_hi:[1,0]
    v_pk_add_f32 v[86:87], v[78:79], 2.0 op_sel_hi:[1,0]
    v_pk_fma_f32 v[80:81], v[72:73], v[80:81], 2.0 op_sel_hi:[1,1,0]
    v_pk_fma_f32 v[82:83], v[74:75], v[82:83], 2.0 op_sel_hi:[1,1,0]
    v_pk_fma_f32 v[84:85], v[76:77], v[84:85], 2.0 op_sel_hi:[1,1,0]
    v_pk_fma_f32 v[86:87], v[78:79], v[86:87], 2.0 op_sel_hi:[1,1,0]
    v_rcp_f32 v80, v80
    v_rcp_f32 v81, v81
    v_rcp_f32 v82, v82
    v_rcp_f32 v83, v83
    v_rcp_f32 v84, v84
    v_rcp_f32 v85, v85
    v_rcp_f32 v86, v86
    v_rcp_f32 v87, v87
    s_nop 0
    v_pk_fma_f32 v[80:81], v[80:81], v[106:107], 1.0 op_sel_hi:[1,1,0]
    v_pk_fma_f32 v[82:83], v[82:83], v[106:107], 1.0 op_sel_hi:[1,1,0]
    v_pk_fma_f32 v[84:85], v[84:85], v[106:107], 1.0 op_sel_hi:[1,1,0]
    v_pk_fma_f32 v[86:87], v[86:87], v[106:107], 1.0 op_sel_hi:[1,1,0]
    v_pk_mul_f32 v[32:33], v[32:33], v[80:81]
    v_pk_mul_f32 v[34:35], v[34:35], v[82:83]
    v_pk_mul_f32 v[36:37], v[36:37], v[84:85]
    v_pk_mul_f32 v[38:39], v[38:39], v[86:87]
    v_pk_mul_f32 v[72:73], v[40:41], v[104:105]
    v_pk_mul_f32 v[74:75], v[42:43], v[104:105]
    v_pk_mul_f32 v[76:77], v[44:45], v[104:105]
    v_pk_mul_f32 v[78:79], v[46:47], v[104:105]
    v_exp_f32 v72, v72
    v_exp_f32 v73, v73
    v_exp_f32 v74, v74
    v_exp_f32 v75, v75
    v_exp_f32 v76, v76
    v_exp_f32 v77, v77
    v_exp_f32 v78, v78
    v_exp_f32 v79, v79
    v_pk_add_f32 v[80:81], v[72:73], 2.0 op_sel_hi:[1,0]
    v_pk_add_f32 v[82:83], v[74:75], 2.0 op_sel_hi:[1,0]
    v_pk_add_f32 v[84:85], v[76:77], 2.0 op_sel_hi:[1,0]
    v_pk_add_f32 v[86:87], v[78:79], 2.0 op_sel_hi:[1,0]
    v_pk_fma_f32 v[80:81], v[72:73], v[80:81], 2.0 op_sel_hi:[1,1,0]
    v_pk_fma_f32 v[82:83], v[74:75], v[82:83], 2.0 op_sel_hi:[1,1,0]
    v_pk_fma_f32 v[84:85], v[76:77], v[84:85], 2.0 op_sel_hi:[1,1,0]
    v_pk_fma_f32 v[86:87], v[78:79], v[86:87], 2.0 op_sel_hi:[1,1,0]
    v_rcp_f32 v80, v80
    v_rcp_f32 v81, v81
    v_rcp_f32 v82, v82
    v_rcp_f32 v83, v83
    v_rcp_f32 v84, v84
    v_rcp_f32 v85, v85
    v_rcp_f32 v86, v86
    v_rcp_f32 v87, v87
    s_nop 0
    v_pk_fma_f32 v[80:81], v[80:81], v[106:107], 1.0 op_sel_hi:[1,1,0]
    v_pk_fma_f32 v[82:83], v[82:83], v[106:107], 1.0 op_sel_hi:[1,1,0]
    v_pk_fma_f32 v[84:85], v[84:85], v[106:107], 1.0 op_sel_hi:[1,1,0]
    v_pk_fma_f32 v[86:87], v[86:87], v[106:107], 1.0 op_sel_hi:[1,1,0]
    v_pk_mul_f32 v[40:41], v[40:41], v[80:81]
    v_pk_mul_f32 v[42:43], v[42:43], v[82:83]
    v_pk_mul_f32 v[44:45], v[44:45], v[84:85]
    v_pk_mul_f32 v[46:47], v[46:47], v[86:87]
    v_cvt_pk_bf16_f32 v64, v32, v33
    v_cvt_pk_bf16_f32 v65, v34, v35
    v_cvt_pk_bf16_f32 v66, v36, v37
    v_cvt_pk_bf16_f32 v67, v38, v39
    v_cvt_pk_bf16_f32 v68, v40, v41
    v_cvt_pk_bf16_f32 v69, v42, v43
    v_cvt_pk_bf16_f32 v70, v44, v45
    v_cvt_pk_bf16_f32 v71, v46, v47
    s_nop 1
    v_permlane32_swap_b32 v64, v66
    v_permlane32_swap_b32 v65, v67
    v_permlane32_swap_b32 v68, v70
    v_permlane32_swap_b32 v69, v71
    buffer_store_dwordx4 v[64:67], v124, s[4:7], s36 offen nt
    s_add_u32 s36, s36, 65536
    buffer_store_dwordx4 v[68:71], v124, s[4:7], s36 offen nt
    s_add_u32 s36, s36, 65536
    s_branch L_k1_fin
L_k1_part1:
    s_cmp_eq_u32 s26, 15
    s_cbranch_scc1 L_k1_gate
    v_xor_b32 v122, 0, v119
    v_lshlrev_b32 v122, 6, v122
    v_lshl_add_u32 v108, v121, 8, v122
    v_add_u32 v108, v108, v120
    v_add_u32 v108, 65536, v108
    v_xor_b32 v122, 1, v119
    v_lshlrev_b32 v122, 6, v122
    v_lshl_add_u32 v109, v121, 8, v122
    v_add_u32 v109, v109, v120
    v_add_u32 v109, 65536, v109
    v_xor_b32 v122, 2, v119
    v_lshlrev_b32 v122, 6, v122
    v_lshl_add_u32 v110, v121, 8, v122
    v_add_u32 v110, v110, v120
    v_add_u32 v110, 65536, v110
    v_xor_b32 v122, 3, v119
    v_lshlrev_b32 v122, 6, v122
    v_lshl_add_u32 v111, v121, 8, v122
    v_add_u32 v111, v111, v120
    v_add_u32 v111, 65536, v111
    s_cmp_ge_u32 s26, 10
    s_cbranch_scc1 L_k1_v
    v_mov_b32 v0, 0
    v_mov_b32 v1, 0
    v_mov_b32 v2, 0
    v_mov_b32 v3, 0
    v_mov_b32 v4, 0
    v_mov_b32 v5, 0
    v_mov_b32 v6, 0
    v_mov_b32 v7, 0
    v_mov_b32 v8, 0
    v_mov_b32 v9, 0
    v_mov_b32 v10, 0
    v_mov_b32 v11, 0
    v_mov_b32 v12, 0
    v_mov_b32 v13, 0
    v_mov_b32 v14, 0
    v_mov_b32 v15, 0
    v_mov_b32 v16, 0
    v_mov_b32 v17, 0
    v_mov_b32 v18, 0
    v_mov_b32 v19, 0
    v_mov_b32 v20, 0
    v_mov_b32 v21, 0
    v_mov_b32 v22, 0
    v_mov_b32 v23, 0
    v_mov_b32 v24, 0
    v_mov_b32 v25, 0
    v_mov_b32 v26, 0
    v_mov_b32 v27, 0
    v_mov_b32 v28, 0
    v_mov_b32 v29, 0
    v_mov_b32 v30, 0
    v_mov_b32 v31, 0
    v_mov_b32 v32, 0
    v_mov_b32 v33, 0
    v_mov_b32 v34, 0
    v_mov_b32 v35, 0
    v_mov_b32 v36, 0
    v_mov_b32 v37, 0
    v_mov_b32 v38, 0
    v_mov_b32 v39, 0
    v_mov_b32 v40, 0
    v_mov_b32 v41, 0
    v_mov_b32 v42, 0
    v_mov_b32 v43, 0
    v_mov_b32 v44, 0
    v_mov_b32 v45, 0
    v_mov_b32 v46, 0
    v_mov_b32 v47, 0
    v_mov_b32 v48, 0
    v_mov_b32 v49, 0
    v_mov_b32 v50, 0
    v_mov_b32 v51, 0
    v_mov_b32 v52, 0
    v_mov_b32 v53, 0
    v_mov_b32 v54, 0
    v_mov_b32 v55, 0
    v_mov_b32 v56, 0
    v_mov_b32 v57, 0
    v_mov_b32 v58, 0
    v_mov_b32 v59, 0
    v_mov_b32 v60, 0
    v_mov_b32 v61, 0
    v_mov_b32 v62, 0
    v_mov_b32 v63, 0
    v_mov_b32 v119, 160064
    s_mov_b32 s36, 1000000
L_k1_poll_qk:
    ds_read_b32 v120, v119
    s_waitcnt lgkmcnt(0)
    v_readfirstlane_b32 s37, v120
    s_cmp_ge_u32 s37, 4
    s_cbranch_scc1 L_k1_go_qk
    s_sub_u32 s36, s36, 1
    s_cmp_eq_u32 s36, 0
    s_cbranch_scc1 L_k1_go_qk
    s_sleep 1
    s_branch L_k1_poll_qk
L_k1_go_qk:
    ds_read_b128 v[64:67], v104 offset:0
    ds_read_b64_tr_b16 v[72:73], v108 offset:0
    ds_read_b64_tr_b16 v[74:75], v108 offset:1024
    ds_read_b64_tr_b16 v[76:77], v109 offset:0
    ds_read_b64_tr_b16 v[78:79], v109 offset:1024
    ds_read_b64_tr_b16 v[80:81], v110 offset:0
    ds_read_b64_tr_b16 v[82:83], v110 offset:1024
    ds_read_b64_tr_b16 v[84:85], v111 offset:0
    ds_read_b64_tr_b16 v[86:87], v111 offset:1024
    s_waitcnt lgkmcnt(0)
    v_mfma_f32_32x32x16_bf16 v[0:15], v[72:75], v[64:67], v[0:15]
    ds_read_b128 v[68:71], v105 offset:0
    ds_read_b64_tr_b16 v[88:89], v108 offset:4096
    ds_read_b64_tr_b16 v[90:91], v108 offset:5120
    v_mfma_f32_32x32x16_bf16 v[16:31], v[76:79], v[64:67], v[16:31]
    ds_read_b64_tr_b16 v[92:93], v109 offset:4096
    ds_read_b64_tr_b16 v[94:95], v109 offset:5120
    ds_read_b64_tr_b16 v[96:97], v110 offset:4096
    v_mfma_f32_32x32x16_bf16 v[32:47], v[80:83], v[64:67], v[32:47]
    ds_read_b64_tr_b16 v[98:99], v110 offset:5120
    ds_read_b64_tr_b16 v[100:101], v111 offset:4096
    ds_read_b64_tr_b16 v[102:103], v111 offset:5120
    v_mfma_f32_32x32x16_bf16 v[48:63], v[84:87], v[64:67], v[48:63]
    s_waitcnt lgkmcnt(0)
    v_mfma_f32_32x32x16_bf16 v[0:15], v[88:91], v[68:71], v[0:15]
    ds_read_b128 v[64:67], v106 offset:0
    ds_read_b64_tr_b16 v[72:73], v108 offset:8192
    ds_read_b64_tr_b16 v[74:75], v108 offset:9216
    v_mfma_f32_32x32x16_bf16 v[16:31], v[92:95], v[68:71], v[16:31]
    ds_read_b64_tr_b16 v[76:77], v109 offset:8192
    ds_read_b64_tr_b16 v[78:79], v109 offset:9216
    ds_read_b64_tr_b16 v[80:81], v110 offset:8192
    v_mfma_f32_32x32x16_bf16 v[32:47], v[96:99], v[68:71], v[32:47]
    ds_read_b64_tr_b16 v[82:83], v110 offset:9216
    ds_read_b64_tr_b16 v[84:85], v111 offset:8192
    ds_read_b64_tr_b16 v[86:87], v111 offset:9216
    v_mfma_f32_32x32x16_bf16 v[48:63], v[100:103], v[68:71], v[48:63]
    s_waitcnt lgkmcnt(0)
    v_mfma_f32_32x32x16_bf16 v[0:15], v[72:75], v[64:67], v[0:15]
    ds_read_b128 v[68:71], v107 offset:0
    ds_read_b64_tr_b16 v[88:89], v108 offset:12288
    ds_read_b64_tr_b16 v[90:91], v108 offset:13312
    v_mfma_f32_32x32x16_bf16 v[16:31], v[76:79], v[64:67], v[16:31]
    ds_read_b64_tr_b16 v[92:93], v109 offset:12288
    ds_read_b64_tr_b16 v[94:95], v109 offset:13312
    ds_read_b64_tr_b16 v[96:97], v110 offset:12288
    v_mfma_f32_32x32x16_bf16 v[32:47], v[80:83], v[64:67], v[32:47]
    ds_read_b64_tr_b16 v[98:99], v110 offset:13312
    ds_read_b64_tr_b16 v[100:101], v111 offset:12288
    ds_read_b64_tr_b16 v[102:103], v111 offset:13312
    v_mfma_f32_32x32x16_bf16 v[48:63], v[84:87], v[64:67], v[48:63]
    s_waitcnt lgkmcnt(0)
    v_mfma_f32_32x32x16_bf16 v[0:15], v[88:91], v[68:71], v[0:15]
    v_mfma_f32_32x32x16_bf16 v[16:31], v[92:95], v[68:71], v[16:31]
    v_mfma_f32_32x32x16_bf16 v[32:47], v[96:99], v[68:71], v[32:47]
    v_mfma_f32_32x32x16_bf16 v[48:63], v[100:103], v[68:71], v[48:63]
    s_barrier
    ds_read_b128 v[64:67], v104 offset:16384
    ds_read_b64_tr_b16 v[72:73], v108 offset:16384
    ds_read_b64_tr_b16 v[74:75], v108 offset:17408
    ds_read_b64_tr_b16 v[76:77], v109 offset:16384
    ds_read_b64_tr_b16 v[78:79], v109 offset:17408
    ds_read_b64_tr_b16 v[80:81], v110 offset:16384
    ds_read_b64_tr_b16 v[82:83], v110 offset:17408
    ds_read_b64_tr_b16 v[84:85], v111 offset:16384
    ds_read_b64_tr_b16 v[86:87], v111 offset:17408
    s_waitcnt lgkmcnt(0)
    v_mfma_f32_32x32x16_bf16 v[0:15], v[72:75], v[64:67], v[0:15]
    ds_read_b128 v[68:71], v105 offset:16384
    ds_read_b64_tr_b16 v[88:89], v108 offset:20480
    ds_read_b64_tr_b16 v[90:91], v108 offset:21504
    v_mfma_f32_32x32x16_bf16 v[16:31], v[76:79], v[64:67], v[16:31]
    ds_read_b64_tr_b16 v[92:93], v109 offset:20480
    ds_read_b64_tr_b16 v[94:95], v109 offset:21504
    ds_read_b64_tr_b16 v[96:97], v110 offset:20480
    v_mfma_f32_32x32x16_bf16 v[32:47], v[80:83], v[64:67], v[32:47]
    ds_read_b64_tr_b16 v[98:99], v110 offset:21504
    ds_read_b64_tr_b16 v[100:101], v111 offset:20480
    ds_read_b64_tr_b16 v[102:103], v111 offset:21504
    v_mfma_f32_32x32x16_bf16 v[48:63], v[84:87], v[64:67], v[48:63]
    s_waitcnt lgkmcnt(0)
    v_mfma_f32_32x32x16_bf16 v[0:15], v[88:91], v[68:71], v[0:15]
    ds_read_b128 v[64:67], v106 offset:16384
    ds_read_b64_tr_b16 v[72:73], v108 offset:24576
    ds_read_b64_tr_b16 v[74:75], v108 offset:25600
    v_mfma_f32_32x32x16_bf16 v[16:31], v[92:95], v[68:71], v[16:31]
    ds_read_b64_tr_b16 v[76:77], v109 offset:24576
    ds_read_b64_tr_b16 v[78:79], v109 offset:25600
    ds_read_b64_tr_b16 v[80:81], v110 offset:24576
    v_mfma_f32_32x32x16_bf16 v[32:47], v[96:99], v[68:71], v[32:47]
    ds_read_b64_tr_b16 v[82:83], v110 offset:25600
    ds_read_b64_tr_b16 v[84:85], v111 offset:24576
    ds_read_b64_tr_b16 v[86:87], v111 offset:25600
    v_mfma_f32_32x32x16_bf16 v[48:63], v[100:103], v[68:71], v[48:63]
    s_waitcnt lgkmcnt(0)
    v_mfma_f32_32x32x16_bf16 v[0:15], v[72:75], v[64:67], v[0:15]
    ds_read_b128 v[68:71], v107 offset:16384
    ds_read_b64_tr_b16 v[88:89], v108 offset:28672
    ds_read_b64_tr_b16 v[90:91], v108 offset:29696
    v_mfma_f32_32x32x16_bf16 v[16:31], v[76:79], v[64:67], v[16:31]
    ds_read_b64_tr_b16 v[92:93], v109 offset:28672
    ds_read_b64_tr_b16 v[94:95], v109 offset:29696
    ds_read_b64_tr_b16 v[96:97], v110 offset:28672
    v_mfma_f32_32x32x16_bf16 v[32:47], v[80:83], v[64:67], v[32:47]
    ds_read_b64_tr_b16 v[98:99], v110 offset:29696
    ds_read_b64_tr_b16 v[100:101], v111 offset:28672
    ds_read_b64_tr_b16 v[102:103], v111 offset:29696
    v_mfma_f32_32x32x16_bf16 v[48:63], v[84:87], v[64:67], v[48:63]
    s_waitcnt lgkmcnt(0)
    v_mfma_f32_32x32x16_bf16 v[0:15], v[88:91], v[68:71], v[0:15]
    ds_read_b128 v[64:67], v104 offset:32768
    ds_read_b64_tr_b16 v[72:73], v108 offset:32768
    ds_read_b64_tr_b16 v[74:75], v108 offset:33792
    v_mfma_f32_32x32x16_bf16 v[16:31], v[92:95], v[68:71], v[16:31]
    ds_read_b64_tr_b16 v[76:77], v109 offset:32768
    ds_read_b64_tr_b16 v[78:79], v109 offset:33792
    ds_read_b64_tr_b16 v[80:81], v110 offset:32768
    v_mfma_f32_32x32x16_bf16 v[32:47], v[96:99], v[68:71], v[32:47]
    ds_read_b64_tr_b16 v[82:83], v110 offset:33792
    ds_read_b64_tr_b16 v[84:85], v111 offset:32768
    ds_read_b64_tr_b16 v[86:87], v111 offset:33792
    v_mfma_f32_32x32x16_bf16 v[48:63], v[100:103], v[68:71], v[48:63]
    s_barrier
    s_waitcnt lgkmcnt(0)
    v_mfma_f32_32x32x16_bf16 v[0:15], v[72:75], v[64:67], v[0:15]
    ds_read_b128 v[68:71], v105 offset:32768
    ds_read_b64_tr_b16 v[88:89], v108 offset:36864
    ds_read_b64_tr_b16 v[90:91], v108 offset:37888
    v_mfma_f32_32x32x16_bf16 v[16:31], v[76:79], v[64:67], v[16:31]
    ds_read_b64_tr_b16 v[92:93], v109 offset:36864
    ds_read_b64_tr_b16 v[94:95], v109 offset:37888
    ds_read_b64_tr_b16 v[96:97], v110 offset:36864
    v_mfma_f32_32x32x16_bf16 v[32:47], v[80:83], v[64:67], v[32:47]
    ds_read_b64_tr_b16 v[98:99], v110 offset:37888
    ds_read_b64_tr_b16 v[100:101], v111 offset:36864
    ds_read_b64_tr_b16 v[102:103], v111 offset:37888
    v_mfma_f32_32x32x16_bf16 v[48:63], v[84:87], v[64:67], v[48:63]
    s_waitcnt lgkmcnt(0)
    v_mfma_f32_32x32x16_bf16 v[0:15], v[88:91], v[68:71], v[0:15]
    ds_read_b128 v[64:67], v106 offset:32768
    ds_read_b64_tr_b16 v[72:73], v108 offset:40960
    ds_read_b64_tr_b16 v[74:75], v108 offset:41984
    v_mfma_f32_32x32x16_bf16 v[16:31], v[92:95], v[68:71], v[16:31]
    ds_read_b64_tr_b16 v[76:77], v109 offset:40960
    ds_read_b64_tr_b16 v[78:79], v109 offset:41984
    ds_read_b64_tr_b16 v[80:81], v110 offset:40960
    v_mfma_f32_32x32x16_bf16 v[32:47], v[96:99], v[68:71], v[32:47]
    ds_read_b64_tr_b16 v[82:83], v110 offset:41984
    ds_read_b64_tr_b16 v[84:85], v111 offset:40960
    ds_read_b64_tr_b16 v[86:87], v111 offset:41984
    v_mfma_f32_32x32x16_bf16 v[48:63], v[100:103], v[68:71], v[48:63]
    s_waitcnt lgkmcnt(0)
    v_mfma_f32_32x32x16_bf16 v[0:15], v[72:75], v[64:67], v[0:15]
    ds_read_b128 v[68:71], v107 offset:32768
    ds_read_b64_tr_b16 v[88:89], v108 offset:45056
    ds_read_b64_tr_b16 v[90:91], v108 offset:46080
    v_mfma_f32_32x32x16_bf16 v[16:31], v[76:79], v[64:67], v[16:31]
    ds_read_b64_tr_b16 v[92:93], v109 offset:45056
    ds_read_b64_tr_b16 v[94:95], v109 offset:46080
    ds_read_b64_tr_b16 v[96:97], v110 offset:45056
    v_mfma_f32_32x32x16_bf16 v[32:47], v[80:83], v[64:67], v[32:47]
    ds_read_b64_tr_b16 v[98:99], v110 offset:46080
    ds_read_b64_tr_b16 v[100:101], v111 offset:45056
    ds_read_b64_tr_b16 v[102:103], v111 offset:46080
    v_mfma_f32_32x32x16_bf16 v[48:63], v[84:87], v[64:67], v[48:63]
    s_waitcnt lgkmcnt(0)
    v_mfma_f32_32x32x16_bf16 v[0:15], v[88:91], v[68:71], v[0:15]
    ds_read_b128 v[64:67], v104 offset:49152
    ds_read_b64_tr_b16 v[72:73], v108 offset:49152
    ds_read_b64_tr_b16 v[74:75], v108 offset:50176
    v_mfma_f32_32x32x16_bf16 v[16:31], v[92:95], v[68:71], v[16:31]
    ds_read_b64_tr_b16 v[76:77], v109 offset:49152
    ds_read_b64_tr_b16 v[78:79], v109 offset:50176
    ds_read_b64_tr_b16 v[80:81], v110 offset:49152
    v_mfma_f32_32x32x16_bf16 v[32:47], v[96:99], v[68:71], v[32:47]
    ds_read_b64_tr_b16 v[82:83], v110 offset:50176
    ds_read_b64_tr_b16 v[84:85], v111 offset:49152
    ds_read_b64_tr_b16 v[86:87], v111 offset:50176
    v_mfma_f32_32x32x16_bf16 v[48:63], v[100:103], v[68:71], v[48:63]
    s_barrier
    s_waitcnt lgkmcnt(0)
    v_mfma_f32_32x32x16_bf16 v[0:15], v[72:75], v[64:67], v[0:15]
    ds_read_b128 v[68:71], v105 offset:49152
    ds_read_b64_tr_b16 v[88:89], v108 offset:0
    ds_read_b64_tr_b16 v[90:91], v108 offset:1024
    v_mfma_f32_32x32x16_bf16 v[16:31], v[76:79], v[64:67], v[16:31]
    ds_read_b64_tr_b16 v[92:93], v109 offset:0
    ds_read_b64_tr_b16 v[94:95], v109 offset:1024
    ds_read_b64_tr_b16 v[96:97], v110 offset:0
    v_mfma_f32_32x32x16_bf16 v[32:47], v[80:83], v[64:67], v[32:47]
    ds_read_b64_tr_b16 v[98:99], v110 offset:1024
    ds_read_b64_tr_b16 v[100:101], v111 offset:0
    ds_read_b64_tr_b16 v[102:103], v111 offset:1024
    v_mfma_f32_32x32x16_bf16 v[48:63], v[84:87], v[64:67], v[48:63]
    s_waitcnt lgkmcnt(0)
    v_mfma_f32_32x32x16_bf16 v[0:15], v[88:91], v[68:71], v[0:15]
    ds_read_b128 v[64:67], v106 offset:49152
    ds_read_b64_tr_b16 v[72:73], v108 offset:4096
    ds_read_b64_tr_b16 v[74:75], v108 offset:5120
    v_mfma_f32_32x32x16_bf16 v[16:31], v[92:95], v[68:71], v[16:31]
    ds_read_b64_tr_b16 v[76:77], v109 offset:4096
    ds_read_b64_tr_b16 v[78:79], v109 offset:5120
    ds_read_b64_tr_b16 v[80:81], v110 offset:4096
    v_mfma_f32_32x32x16_bf16 v[32:47], v[96:99], v[68:71], v[32:47]
    ds_read_b64_tr_b16 v[82:83], v110 offset:5120
    ds_read_b64_tr_b16 v[84:85], v111 offset:4096
    ds_read_b64_tr_b16 v[86:87], v111 offset:5120
    v_mfma_f32_32x32x16_bf16 v[48:63], v[100:103], v[68:71], v[48:63]
    s_waitcnt lgkmcnt(0)
    v_mfma_f32_32x32x16_bf16 v[0:15], v[72:75], v[64:67], v[0:15]
    ds_read_b128 v[68:71], v107 offset:49152
    ds_read_b64_tr_b16 v[88:89], v108 offset:8192
    ds_read_b64_tr_b16 v[90:91], v108 offset:9216
    v_mfma_f32_32x32x16_bf16 v[16:31], v[76:79], v[64:67], v[16:31]
    ds_read_b64_tr_b16 v[92:93], v109 offset:8192
    ds_read_b64_tr_b16 v[94:95], v109 offset:9216
    ds_read_b64_tr_b16 v[96:97], v110 offset:8192
    v_mfma_f32_32x32x16_bf16 v[32:47], v[80:83], v[64:67], v[32:47]
    ds_read_b64_tr_b16 v[98:99], v110 offset:9216
    ds_read_b64_tr_b16 v[100:101], v111 offset:8192
    ds_read_b64_tr_b16 v[102:103], v111 offset:9216
    v_mfma_f32_32x32x16_bf16 v[48:63], v[84:87], v[64:67], v[48:63]
    s_waitcnt lgkmcnt(0)
    v_mfma_f32_32x32x16_bf16 v[0:15], v[88:91], v[68:71], v[0:15]
    ds_read_b128 v[64:67], v104 offset:0
    ds_read_b64_tr_b16 v[72:73], v108 offset:12288
    ds_read_b64_tr_b16 v[74:75], v108 offset:13312
    v_mfma_f32_32x32x16_bf16 v[16:31], v[92:95], v[68:71], v[16:31]
    ds_read_b64_tr_b16 v[76:77], v109 offset:12288
    ds_read_b64_tr_b16 v[78:79], v109 offset:13312
    ds_read_b64_tr_b16 v[80:81], v110 offset:12288
    v_mfma_f32_32x32x16_bf16 v[32:47], v[96:99], v[68:71], v[32:47]
    ds_read_b64_tr_b16 v[82:83], v110 offset:13312
    ds_read_b64_tr_b16 v[84:85], v111 offset:12288
    ds_read_b64_tr_b16 v[86:87], v111 offset:13312
    v_mfma_f32_32x32x16_bf16 v[48:63], v[100:103], v[68:71], v[48:63]
    s_barrier
    s_waitcnt lgkmcnt(0)
    v_mfma_f32_32x32x16_bf16 v[0:15], v[72:75], v[64:67], v[0:15]
    ds_read_b128 v[68:71], v105 offset:0
    ds_read_b64_tr_b16 v[88:89], v108 offset:16384
    ds_read_b64_tr_b16 v[90:91], v108 offset:17408
    v_mfma_f32_32x32x16_bf16 v[16:31], v[76:79], v[64:67], v[16:31]
    ds_read_b64_tr_b16 v[92:93], v109 offset:16384
    ds_read_b64_tr_b16 v[94:95], v109 offset:17408
    ds_read_b64_tr_b16 v[96:97], v110 offset:16384
    v_mfma_f32_32x32x16_bf16 v[32:47], v[80:83], v[64:67], v[32:47]
    ds_read_b64_tr_b16 v[98:99], v110 offset:17408
    ds_read_b64_tr_b16 v[100:101], v111 offset:16384
    ds_read_b64_tr_b16 v[102:103], v111 offset:17408
    v_mfma_f32_32x32x16_bf16 v[48:63], v[84:87], v[64:67], v[48:63]
    s_waitcnt lgkmcnt(0)
    v_mfma_f32_32x32x16_bf16 v[0:15], v[88:91], v[68:71], v[0:15]
    ds_read_b128 v[64:67], v106 offset:0
    ds_read_b64_tr_b16 v[72:73], v108 offset:20480
    ds_read_b64_tr_b16 v[74:75], v108 offset:21504
    v_mfma_f32_32x32x16_bf16 v[16:31], v[92:95], v[68:71], v[16:31]
    ds_read_b64_tr_b16 v[76:77], v109 offset:20480
    ds_read_b64_tr_b16 v[78:79], v109 offset:21504
    ds_read_b64_tr_b16 v[80:81], v110 offset:20480
    v_mfma_f32_32x32x16_bf16 v[32:47], v[96:99], v[68:71], v[32:47]
    ds_read_b64_tr_b16 v[82:83], v110 offset:21504
    ds_read_b64_tr_b16 v[84:85], v111 offset:20480
    ds_read_b64_tr_b16 v[86:87], v111 offset:21504
    v_mfma_f32_32x32x16_bf16 v[48:63], v[100:103], v[68:71], v[48:63]
    s_waitcnt lgkmcnt(0)
    v_mfma_f32_32x32x16_bf16 v[0:15], v[72:75], v[64:67], v[0:15]
    ds_read_b128 v[68:71], v107 offset:0
    ds_read_b64_tr_b16 v[88:89], v108 offset:24576
    ds_read_b64_tr_b16 v[90:91], v108 offset:25600
    v_mfma_f32_32x32x16_bf16 v[16:31], v[76:79], v[64:67], v[16:31]
    ds_read_b64_tr_b16 v[92:93], v109 offset:24576
    ds_read_b64_tr_b16 v[94:95], v109 offset:25600
    ds_read_b64_tr_b16 v[96:97], v110 offset:24576
    v_mfma_f32_32x32x16_bf16 v[32:47], v[80:83], v[64:67], v[32:47]
    ds_read_b64_tr_b16 v[98:99], v110 offset:25600
    ds_read_b64_tr_b16 v[100:101], v111 offset:24576
    ds_read_b64_tr_b16 v[102:103], v111 offset:25600
    v_mfma_f32_32x32x16_bf16 v[48:63], v[84:87], v[64:67], v[48:63]
    s_waitcnt lgkmcnt(0)
    v_mfma_f32_32x32x16_bf16 v[0:15], v[88:91], v[68:71], v[0:15]
    ds_read_b128 v[64:67], v104 offset:16384
    ds_read_b64_tr_b16 v[72:73], v108 offset:28672
    ds_read_b64_tr_b16 v[74:75], v108 offset:29696
    v_mfma_f32_32x32x16_bf16 v[16:31], v[92:95], v[68:71], v[16:31]
    ds_read_b64_tr_b16 v[76:77], v109 offset:28672
    ds_read_b64_tr_b16 v[78:79], v109 offset:29696
    ds_read_b64_tr_b16 v[80:81], v110 offset:28672
    v_mfma_f32_32x32x16_bf16 v[32:47], v[96:99], v[68:71], v[32:47]
    ds_read_b64_tr_b16 v[82:83], v110 offset:29696
    ds_read_b64_tr_b16 v[84:85], v111 offset:28672
    ds_read_b64_tr_b16 v[86:87], v111 offset:29696
    v_mfma_f32_32x32x16_bf16 v[48:63], v[100:103], v[68:71], v[48:63]
    s_barrier
    s_waitcnt lgkmcnt(0)
    v_mfma_f32_32x32x16_bf16 v[0:15], v[72:75], v[64:67], v[0:15]
    ds_read_b128 v[68:71], v105 offset:16384
    ds_read_b64_tr_b16 v[88:89], v108 offset:32768
    ds_read_b64_tr_b16 v[90:91], v108 offset:33792
    v_mfma_f32_32x32x16_bf16 v[16:31], v[76:79], v[64:67], v[16:31]
    ds_read_b64_tr_b16 v[92:93], v109 offset:32768
    ds_read_b64_tr_b16 v[94:95], v109 offset:33792
    ds_read_b64_tr_b16 v[96:97], v110 offset:32768
    v_mfma_f32_32x32x16_bf16 v[32:47], v[80:83], v[64:67], v[32:47]
    ds_read_b64_tr_b16 v[98:99], v110 offset:33792
    ds_read_b64_tr_b16 v[100:101], v111 offset:32768
    ds_read_b64_tr_b16 v[102:103], v111 offset:33792
    v_mfma_f32_32x32x16_bf16 v[48:63], v[84:87], v[64:67], v[48:63]
    s_waitcnt lgkmcnt(0)
    v_mfma_f32_32x32x16_bf16 v[0:15], v[88:91], v[68:71], v[0:15]
    ds_read_b128 v[64:67], v106 offset:16384
    ds_read_b64_tr_b16 v[72:73], v108 offset:36864
    ds_read_b64_tr_b16 v[74:75], v108 offset:37888
    v_mfma_f32_32x32x16_bf16 v[16:31], v[92:95], v[68:71], v[16:31]
    ds_read_b64_tr_b16 v[76:77], v109 offset:36864
    ds_read_b64_tr_b16 v[78:79], v109 offset:37888
    ds_read_b64_tr_b16 v[80:81], v110 offset:36864
    v_mfma_f32_32x32x16_bf16 v[32:47], v[96:99], v[68:71], v[32:47]
    ds_read_b64_tr_b16 v[82:83], v110 offset:37888
    ds_read_b64_tr_b16 v[84:85], v111 offset:36864
    ds_read_b64_tr_b16 v[86:87], v111 offset:37888
    v_mfma_f32_32x32x16_bf16 v[48:63], v[100:103], v[68:71], v[48:63]
    s_waitcnt lgkmcnt(0)
    v_mfma_f32_32x32x16_bf16 v[0:15], v[72:75], v[64:67], v[0:15]
    ds_read_b128 v[68:71], v107 offset:16384
    ds_read_b64_tr_b16 v[88:89], v108 offset:40960
    ds_read_b64_tr_b16 v[90:91], v108 offset:41984
    v_mfma_f32_32x32x16_bf16 v[16:31], v[76:79], v[64:67], v[16:31]
    ds_read_b64_tr_b16 v[92:93], v109 offset:40960
    ds_read_b64_tr_b16 v[94:95], v109 offset:41984
    ds_read_b64_tr_b16 v[96:97], v110 offset:40960
    v_mfma_f32_32x32x16_bf16 v[32:47], v[80:83], v[64:67], v[32:47]
    ds_read_b64_tr_b16 v[98:99], v110 offset:41984
    ds_read_b64_tr_b16 v[100:101], v111 offset:40960
    ds_read_b64_tr_b16 v[102:103], v111 offset:41984
    v_mfma_f32_32x32x16_bf16 v[48:63], v[84:87], v[64:67], v[48:63]
    s_waitcnt lgkmcnt(0)
    v_mfma_f32_32x32x16_bf16 v[0:15], v[88:91], v[68:71], v[0:15]
    ds_read_b128 v[64:67], v104 offset:32768
    ds_read_b64_tr_b16 v[72:73], v108 offset:45056
    ds_read_b64_tr_b16 v[74:75], v108 offset:46080
    v_mfma_f32_32x32x16_bf16 v[16:31], v[92:95], v[68:71], v[16:31]
    ds_read_b64_tr_b16 v[76:77], v109 offset:45056
    ds_read_b64_tr_b16 v[78:79], v109 offset:46080
    ds_read_b64_tr_b16 v[80:81], v110 offset:45056
    v_mfma_f32_32x32x16_bf16 v[32:47], v[96:99], v[68:71], v[32:47]
    ds_read_b64_tr_b16 v[82:83], v110 offset:46080
    ds_read_b64_tr_b16 v[84:85], v111 offset:45056
    ds_read_b64_tr_b16 v[86:87], v111 offset:46080
    v_mfma_f32_32x32x16_bf16 v[48:63], v[100:103], v[68:71], v[48:63]
    s_barrier
    s_waitcnt lgkmcnt(0)
    v_mfma_f32_32x32x16_bf16 v[0:15], v[72:75], v[64:67], v[0:15]
    ds_read_b128 v[68:71], v105 offset:32768
    ds_read_b64_tr_b16 v[88:89], v108 offset:49152
    ds_read_b64_tr_b16 v[90:91], v108 offset:50176
    v_mfma_f32_32x32x16_bf16 v[16:31], v[76:79], v[64:67], v[16:31]
    ds_read_b64_tr_b16 v[92:93], v109 offset:49152
    ds_read_b64_tr_b16 v[94:95], v109 offset:50176
    ds_read_b64_tr_b16 v[96:97], v110 offset:49152
    v_mfma_f32_32x32x16_bf16 v[32:47], v[80:83], v[64:67], v[32:47]
    ds_read_b64_tr_b16 v[98:99], v110 offset:50176
    ds_read_b64_tr_b16 v[100:101], v111 offset:49152
    ds_read_b64_tr_b16 v[102:103], v111 offset:50176
    v_mfma_f32_32x32x16_bf16 v[48:63], v[84:87], v[64:67], v[48:63]
    s_waitcnt lgkmcnt(0)
    v_mfma_f32_32x32x16_bf16 v[0:15], v[88:91], v[68:71], v[0:15]
    ds_read_b128 v[64:67], v106 offset:32768
    ds_read_b64_tr_b16 v[72:73], v108 offset:0
    ds_read_b64_tr_b16 v[74:75], v108 offset:1024
    v_mfma_f32_32x32x16_bf16 v[16:31], v[92:95], v[68:71], v[16:31]
    ds_read_b64_tr_b16 v[76:77], v109 offset:0
    ds_read_b64_tr_b16 v[78:79], v109 offset:1024
    ds_read_b64_tr_b16 v[80:81], v110 offset:0
    v_mfma_f32_32x32x16_bf16 v[32:47], v[96:99], v[68:71], v[32:47]
    ds_read_b64_tr_b16 v[82:83], v110 offset:1024
    ds_read_b64_tr_b16 v[84:85], v111 offset:0
    ds_read_b64_tr_b16 v[86:87], v111 offset:1024
    v_mfma_f32_32x32x16_bf16 v[48:63], v[100:103], v[68:71], v[48:63]
    s_waitcnt lgkmcnt(0)
    v_mfma_f32_32x32x16_bf16 v[0:15], v[72:75], v[64:67], v[0:15]
    ds_read_b128 v[68:71], v107 offset:32768
    ds_read_b64_tr_b16 v[88:89], v108 offset:4096
    ds_read_b64_tr_b16 v[90:91], v108 offset:5120
    v_mfma_f32_32x32x16_bf16 v[16:31], v[76:79], v[64:67], v[16:31]
    ds_read_b64_tr_b16 v[92:93], v109 offset:4096
    ds_read_b64_tr_b16 v[94:95], v109 offset:5120
    ds_read_b64_tr_b16 v[96:97], v110 offset:4096
    v_mfma_f32_32x32x16_bf16 v[32:47], v[80:83], v[64:67], v[32:47]
    ds_read_b64_tr_b16 v[98:99], v110 offset:5120
    ds_read_b64_tr_b16 v[100:101], v111 offset:4096
    ds_read_b64_tr_b16 v[102:103], v111 offset:5120
    v_mfma_f32_32x32x16_bf16 v[48:63], v[84:87], v[64:67], v[48:63]
    s_waitcnt lgkmcnt(0)
    v_mfma_f32_32x32x16_bf16 v[0:15], v[88:91], v[68:71], v[0:15]
    ds_read_b128 v[64:67], v104 offset:49152
    ds_read_b64_tr_b16 v[72:73], v108 offset:8192
    ds_read_b64_tr_b16 v[74:75], v108 offset:9216
    v_mfma_f32_32x32x16_bf16 v[16:31], v[92:95], v[68:71], v[16:31]
    ds_read_b64_tr_b16 v[76:77], v109 offset:8192
    ds_read_b64_tr_b16 v[78:79], v109 offset:9216
    ds_read_b64_tr_b16 v[80:81], v110 offset:8192
    v_mfma_f32_32x32x16_bf16 v[32:47], v[96:99], v[68:71], v[32:47]
    ds_read_b64_tr_b16 v[82:83], v110 offset:9216
    ds_read_b64_tr_b16 v[84:85], v111 offset:8192
    ds_read_b64_tr_b16 v[86:87], v111 offset:9216
    v_mfma_f32_32x32x16_bf16 v[48:63], v[100:103], v[68:71], v[48:63]
    s_barrier
    s_waitcnt lgkmcnt(0)
    v_mfma_f32_32x32x16_bf16 v[0:15], v[72:75], v[64:67], v[0:15]
    ds_read_b128 v[68:71], v105 offset:49152
    ds_read_b64_tr_b16 v[88:89], v108 offset:12288
    ds_read_b64_tr_b16 v[90:91], v108 offset:13312
    v_mfma_f32_32x32x16_bf16 v[16:31], v[76:79], v[64:67], v[16:31]
    ds_read_b64_tr_b16 v[92:93], v109 offset:12288
    ds_read_b64_tr_b16 v[94:95], v109 offset:13312
    ds_read_b64_tr_b16 v[96:97], v110 offset:12288
    v_mfma_f32_32x32x16_bf16 v[32:47], v[80:83], v[64:67], v[32:47]
    ds_read_b64_tr_b16 v[98:99], v110 offset:13312
    ds_read_b64_tr_b16 v[100:101], v111 offset:12288
    ds_read_b64_tr_b16 v[102:103], v111 offset:13312
    v_mfma_f32_32x32x16_bf16 v[48:63], v[84:87], v[64:67], v[48:63]
    s_waitcnt lgkmcnt(0)
    v_mfma_f32_32x32x16_bf16 v[0:15], v[88:91], v[68:71], v[0:15]
    ds_read_b128 v[64:67], v106 offset:49152
    ds_read_b64_tr_b16 v[72:73], v108 offset:16384
    ds_read_b64_tr_b16 v[74:75], v108 offset:17408
    v_mfma_f32_32x32x16_bf16 v[16:31], v[92:95], v[68:71], v[16:31]
    ds_read_b64_tr_b16 v[76:77], v109 offset:16384
    ds_read_b64_tr_b16 v[78:79], v109 offset:17408
    ds_read_b64_tr_b16 v[80:81], v110 offset:16384
    v_mfma_f32_32x32x16_bf16 v[32:47], v[96:99], v[68:71], v[32:47]
    ds_read_b64_tr_b16 v[82:83], v110 offset:17408
    ds_read_b64_tr_b16 v[84:85], v111 offset:16384
    ds_read_b64_tr_b16 v[86:87], v111 offset:17408
    v_mfma_f32_32x32x16_bf16 v[48:63], v[100:103], v[68:71], v[48:63]
    s_waitcnt lgkmcnt(0)
    v_mfma_f32_32x32x16_bf16 v[0:15], v[72:75], v[64:67], v[0:15]
    ds_read_b128 v[68:71], v107 offset:49152
    ds_read_b64_tr_b16 v[88:89], v108 offset:20480
    ds_read_b64_tr_b16 v[90:91], v108 offset:21504
    v_mfma_f32_32x32x16_bf16 v[16:31], v[76:79], v[64:67], v[16:31]
    ds_read_b64_tr_b16 v[92:93], v109 offset:20480
    ds_read_b64_tr_b16 v[94:95], v109 offset:21504
    ds_read_b64_tr_b16 v[96:97], v110 offset:20480
    v_mfma_f32_32x32x16_bf16 v[32:47], v[80:83], v[64:67], v[32:47]
    ds_read_b64_tr_b16 v[98:99], v110 offset:21504
    ds_read_b64_tr_b16 v[100:101], v111 offset:20480
    ds_read_b64_tr_b16 v[102:103], v111 offset:21504
    v_mfma_f32_32x32x16_bf16 v[48:63], v[84:87], v[64:67], v[48:63]
    s_waitcnt lgkmcnt(0)
    v_mfma_f32_32x32x16_bf16 v[0:15], v[88:91], v[68:71], v[0:15]
    ds_read_b128 v[64:67], v104 offset:0
    ds_read_b64_tr_b16 v[72:73], v108 offset:24576
    ds_read_b64_tr_b16 v[74:75], v108 offset:25600
    v_mfma_f32_32x32x16_bf16 v[16:31], v[92:95], v[68:71], v[16:31]
    ds_read_b64_tr_b16 v[76:77], v109 offset:24576
    ds_read_b64_tr_b16 v[78:79], v109 offset:25600
    ds_read_b64_tr_b16 v[80:81], v110 offset:24576
    v_mfma_f32_32x32x16_bf16 v[32:47], v[96:99], v[68:71], v[32:47]
    ds_read_b64_tr_b16 v[82:83], v110 offset:25600
    ds_read_b64_tr_b16 v[84:85], v111 offset:24576
    ds_read_b64_tr_b16 v[86:87], v111 offset:25600
    v_mfma_f32_32x32x16_bf16 v[48:63], v[100:103], v[68:71], v[48:63]
    s_barrier
    s_waitcnt lgkmcnt(0)
    v_mfma_f32_32x32x16_bf16 v[0:15], v[72:75], v[64:67], v[0:15]
    ds_read_b128 v[68:71], v105 offset:0
    ds_read_b64_tr_b16 v[88:89], v108 offset:28672
    ds_read_b64_tr_b16 v[90:91], v108 offset:29696
    v_mfma_f32_32x32x16_bf16 v[16:31], v[76:79], v[64:67], v[16:31]
    ds_read_b64_tr_b16 v[92:93], v109 offset:28672
    ds_read_b64_tr_b16 v[94:95], v109 offset:29696
    ds_read_b64_tr_b16 v[96:97], v110 offset:28672
    v_mfma_f32_32x32x16_bf16 v[32:47], v[80:83], v[64:67], v[32:47]
    ds_read_b64_tr_b16 v[98:99], v110 offset:29696
    ds_read_b64_tr_b16 v[100:101], v111 offset:28672
    ds_read_b64_tr_b16 v[102:103], v111 offset:29696
    v_mfma_f32_32x32x16_bf16 v[48:63], v[84:87], v[64:67], v[48:63]
    s_waitcnt lgkmcnt(0)
    v_mfma_f32_32x32x16_bf16 v[0:15], v[88:91], v[68:71], v[0:15]
    ds_read_b128 v[64:67], v106 offset:0
    ds_read_b64_tr_b16 v[72:73], v108 offset:32768
    ds_read_b64_tr_b16 v[74:75], v108 offset:33792
    v_mfma_f32_32x32x16_bf16 v[16:31], v[92:95], v[68:71], v[16:31]
    ds_read_b64_tr_b16 v[76:77], v109 offset:32768
    ds_read_b64_tr_b16 v[78:79], v109 offset:33792
    ds_read_b64_tr_b16 v[80:81], v110 offset:32768
    v_mfma_f32_32x32x16_bf16 v[32:47], v[96:99], v[68:71], v[32:47]
    ds_read_b64_tr_b16 v[82:83], v110 offset:33792
    ds_read_b64_tr_b16 v[84:85], v111 offset:32768
    ds_read_b64_tr_b16 v[86:87], v111 offset:33792
    v_mfma_f32_32x32x16_bf16 v[48:63], v[100:103], v[68:71], v[48:63]
    s_waitcnt lgkmcnt(0)
    v_mfma_f32_32x32x16_bf16 v[0:15], v[72:75], v[64:67], v[0:15]
    ds_read_b128 v[68:71], v107 offset:0
    ds_read_b64_tr_b16 v[88:89], v108 offset:36864
    ds_read_b64_tr_b16 v[90:91], v108 offset:37888
    v_mfma_f32_32x32x16_bf16 v[16:31], v[76:79], v[64:67], v[16:31]
    ds_read_b64_tr_b16 v[92:93], v109 offset:36864
    ds_read_b64_tr_b16 v[94:95], v109 offset:37888
    ds_read_b64_tr_b16 v[96:97], v110 offset:36864
    v_mfma_f32_32x32x16_bf16 v[32:47], v[80:83], v[64:67], v[32:47]
    ds_read_b64_tr_b16 v[98:99], v110 offset:37888
    ds_read_b64_tr_b16 v[100:101], v111 offset:36864
    ds_read_b64_tr_b16 v[102:103], v111 offset:37888
    v_mfma_f32_32x32x16_bf16 v[48:63], v[84:87], v[64:67], v[48:63]
    s_waitcnt lgkmcnt(0)
    v_mfma_f32_32x32x16_bf16 v[0:15], v[88:91], v[68:71], v[0:15]
    ds_read_b128 v[64:67], v104 offset:16384
    ds_read_b64_tr_b16 v[72:73], v108 offset:40960
    ds_read_b64_tr_b16 v[74:75], v108 offset:41984
    v_mfma_f32_32x32x16_bf16 v[16:31], v[92:95], v[68:71], v[16:31]
    ds_read_b64_tr_b16 v[76:77], v109 offset:40960
    ds_read_b64_tr_b16 v[78:79], v109 offset:41984
    ds_read_b64_tr_b16 v[80:81], v110 offset:40960
    v_mfma_f32_32x32x16_bf16 v[32:47], v[96:99], v[68:71], v[32:47]
    ds_read_b64_tr_b16 v[82:83], v110 offset:41984
    ds_read_b64_tr_b16 v[84:85], v111 offset:40960
    ds_read_b64_tr_b16 v[86:87], v111 offset:41984
    v_mfma_f32_32x32x16_bf16 v[48:63], v[100:103], v[68:71], v[48:63]
    s_barrier
    s_waitcnt lgkmcnt(0)
    v_mfma_f32_32x32x16_bf16 v[0:15], v[72:75], v[64:67], v[0:15]
    ds_read_b128 v[68:71], v105 offset:16384
    ds_read_b64_tr_b16 v[88:89], v108 offset:45056
    ds_read_b64_tr_b16 v[90:91], v108 offset:46080
    v_mfma_f32_32x32x16_bf16 v[16:31], v[76:79], v[64:67], v[16:31]
    ds_read_b64_tr_b16 v[92:93], v109 offset:45056
    ds_read_b64_tr_b16 v[94:95], v109 offset:46080
    ds_read_b64_tr_b16 v[96:97], v110 offset:45056
    v_mfma_f32_32x32x16_bf16 v[32:47], v[80:83], v[64:67], v[32:47]
    ds_read_b64_tr_b16 v[98:99], v110 offset:46080
    ds_read_b64_tr_b16 v[100:101], v111 offset:45056
    ds_read_b64_tr_b16 v[102:103], v111 offset:46080
    v_mfma_f32_32x32x16_bf16 v[48:63], v[84:87], v[64:67], v[48:63]
    s_waitcnt lgkmcnt(0)
    v_mfma_f32_32x32x16_bf16 v[0:15], v[88:91], v[68:71], v[0:15]
    ds_read_b128 v[64:67], v106 offset:16384
    ds_read_b64_tr_b16 v[72:73], v108 offset:49152
    ds_read_b64_tr_b16 v[74:75], v108 offset:50176
    v_mfma_f32_32x32x16_bf16 v[16:31], v[92:95], v[68:71], v[16:31]
    ds_read_b64_tr_b16 v[76:77], v109 offset:49152
    ds_read_b64_tr_b16 v[78:79], v109 offset:50176
    ds_read_b64_tr_b16 v[80:81], v110 offset:49152
    v_mfma_f32_32x32x16_bf16 v[32:47], v[96:99], v[68:71], v[32:47]
    ds_read_b64_tr_b16 v[82:83], v110 offset:50176
    ds_read_b64_tr_b16 v[84:85], v111 offset:49152
    ds_read_b64_tr_b16 v[86:87], v111 offset:50176
    v_mfma_f32_32x32x16_bf16 v[48:63], v[100:103], v[68:71], v[48:63]
    s_waitcnt lgkmcnt(0)
    v_mfma_f32_32x32x16_bf16 v[0:15], v[72:75], v[64:67], v[0:15]
    ds_read_b128 v[68:71], v107 offset:16384
    ds_read_b64_tr_b16 v[88:89], v108 offset:0
    ds_read_b64_tr_b16 v[90:91], v108 offset:1024
    v_mfma_f32_32x32x16_bf16 v[16:31], v[76:79], v[64:67], v[16:31]
    ds_read_b64_tr_b16 v[92:93], v109 offset:0
    ds_read_b64_tr_b16 v[94:95], v109 offset:1024
    ds_read_b64_tr_b16 v[96:97], v110 offset:0
    v_mfma_f32_32x32x16_bf16 v[32:47], v[80:83], v[64:67], v[32:47]
    ds_read_b64_tr_b16 v[98:99], v110 offset:1024
    ds_read_b64_tr_b16 v[100:101], v111 offset:0
    ds_read_b64_tr_b16 v[102:103], v111 offset:1024
    v_mfma_f32_32x32x16_bf16 v[48:63], v[84:87], v[64:67], v[48:63]
    s_waitcnt lgkmcnt(0)
    v_mfma_f32_32x32x16_bf16 v[0:15], v[88:91], v[68:71], v[0:15]
    v_mfma_f32_32x32x16_bf16 v[16:31], v[92:95], v[68:71], v[16:31]
    v_mfma_f32_32x32x16_bf16 v[32:47], v[96:99], v[68:71], v[32:47]
    v_mfma_f32_32x32x16_bf16 v[48:63], v[100:103], v[68:71], v[48:63]
    s_nop 15
    s_cmp_lt_u32 s26, 5
    s_mov_b32 s42, 0x3f800000
    s_cselect_b32 s42, 0x3ea52b5c, s42
    v_mov_b32 v104, s42
    v_mov_b32 v105, s42
    v_lshlrev_b32 v119, 14, v118
    v_lshl_add_u32 v119, v117, 3, v119
    s_lshl_b32 s36, s25, 7
    s_lshl_b32 s37, s27, 5
    s_add_u32 s36, s36, s37
    s_lshl_b32 s36, s36, 3
    s_lshl_b32 s37, s26, 19
    s_add_u32 s36, s36, s37
    s_add_u32 s36, s36, 0
    v_pk_mul_f32 v[0:1], v[0:1], v[104:105]
    v_pk_mul_f32 v[2:3], v[2:3], v[104:105]
    v_cvt_pk_bf16_f32 v0, v0, v1
    v_cvt_pk_bf16_f32 v1, v2, v3
    buffer_store_dwordx2 v[0:1], v119, s[4:7], s36 offen
    s_add_u32 s36, s36, 32768
    v_pk_mul_f32 v[4:5], v[4:5], v[104:105]
    v_pk_mul_f32 v[6:7], v[6:7], v[104:105]
    v_cvt_pk_bf16_f32 v4, v4, v5
    v_cvt_pk_bf16_f32 v5, v6, v7
    buffer_store_dwordx2 v[4:5], v119, s[4:7], s36 offen
    s_add_u32 s36, s36, 32768
    v_pk_mul_f32 v[8:9], v[8:9], v[104:105]
    v_pk_mul_f32 v[10:11], v[10:11], v[104:105]
    v_cvt_pk_bf16_f32 v8, v8, v9
    v_cvt_pk_bf16_f32 v9, v10, v11
    buffer_store_dwordx2 v[8:9], v119, s[4:7], s36 offen
    s_add_u32 s36, s36, 32768
    v_pk_mul_f32 v[12:13], v[12:13], v[104:105]
    v_pk_mul_f32 v[14:15], v[14:15], v[104:105]
    v_cvt_pk_bf16_f32 v12, v12, v13
    v_cvt_pk_bf16_f32 v13, v14, v15
    buffer_store_dwordx2 v[12:13], v119, s[4:7], s36 offen
    s_add_u32 s36, s36, 32768
    v_pk_mul_f32 v[16:17], v[16:17], v[104:105]
    v_pk_mul_f32 v[18:19], v[18:19], v[104:105]
    v_cvt_pk_bf16_f32 v16, v16, v17
    v_cvt_pk_bf16_f32 v17, v18, v19
    buffer_store_dwordx2 v[16:17], v119, s[4:7], s36 offen
    s_add_u32 s36, s36, 32768
    v_pk_mul_f32 v[20:21], v[20:21], v[104:105]
    v_pk_mul_f32 v[22:23], v[22:23], v[104:105]
    v_cvt_pk_bf16_f32 v20, v20, v21
    v_cvt_pk_bf16_f32 v21, v22, v23
    buffer_store_dwordx2 v[20:21], v119, s[4:7], s36 offen
    s_add_u32 s36, s36, 32768
    v_pk_mul_f32 v[24:25], v[24:25], v[104:105]
    v_pk_mul_f32 v[26:27], v[26:27], v[104:105]
    v_cvt_pk_bf16_f32 v24, v24, v25
    v_cvt_pk_bf16_f32 v25, v26, v27
    buffer_store_dwordx2 v[24:25], v119, s[4:7], s36 offen
    s_add_u32 s36, s36, 32768
    v_pk_mul_f32 v[28:29], v[28:29], v[104:105]
    v_pk_mul_f32 v[30:31], v[30:31], v[104:105]
    v_cvt_pk_bf16_f32 v28, v28, v29
    v_cvt_pk_bf16_f32 v29, v30, v31
    buffer_store_dwordx2 v[28:29], v119, s[4:7], s36 offen
    s_add_u32 s36, s36, 32768
    v_pk_mul_f32 v[32:33], v[32:33], v[104:105]
    v_pk_mul_f32 v[34:35], v[34:35], v[104:105]
    v_cvt_pk_bf16_f32 v32, v32, v33
    v_cvt_pk_bf16_f32 v33, v34, v35
    buffer_store_dwordx2 v[32:33], v119, s[4:7], s36 offen
    s_add_u32 s36, s36, 32768
    v_pk_mul_f32 v[36:37], v[36:37], v[104:105]
    v_pk_mul_f32 v[38:39], v[38:39], v[104:105]
    v_cvt_pk_bf16_f32 v36, v36, v37
    v_cvt_pk_bf16_f32 v37, v38, v39
    buffer_store_dwordx2 v[36:37], v119, s[4:7], s36 offen
    s_add_u32 s36, s36, 32768
    v_pk_mul_f32 v[40:41], v[40:41], v[104:105]
    v_pk_mul_f32 v[42:43], v[42:43], v[104:105]
    v_cvt_pk_bf16_f32 v40, v40, v41
    v_cvt_pk_bf16_f32 v41, v42, v43
    buffer_store_dwordx2 v[40:41], v119, s[4:7], s36 offen
    s_add_u32 s36, s36, 32768
    v_pk_mul_f32 v[44:45], v[44:45], v[104:105]
    v_pk_mul_f32 v[46:47], v[46:47], v[104:105]
    v_cvt_pk_bf16_f32 v44, v44, v45
    v_cvt_pk_bf16_f32 v45, v46, v47
    buffer_store_dwordx2 v[44:45], v119, s[4:7], s36 offen
    s_add_u32 s36, s36, 32768
    v_pk_mul_f32 v[48:49], v[48:49], v[104:105]
    v_pk_mul_f32 v[50:51], v[50:51], v[104:105]
    v_cvt_pk_bf16_f32 v48, v48, v49
    v_cvt_pk_bf16_f32 v49, v50, v51
    buffer_store_dwordx2 v[48:49], v119, s[4:7], s36 offen
    s_add_u32 s36, s36, 32768
    v_pk_mul_f32 v[52:53], v[52:53], v[104:105]
    v_pk_mul_f32 v[54:55], v[54:55], v[104:105]
    v_cvt_pk_bf16_f32 v52, v52, v53
    v_cvt_pk_bf16_f32 v53, v54, v55
    buffer_store_dwordx2 v[52:53], v119, s[4:7], s36 offen
    s_add_u32 s36, s36, 32768
    v_pk_mul_f32 v[56:57], v[56:57], v[104:105]
    v_pk_mul_f32 v[58:59], v[58:59], v[104:105]
    v_cvt_pk_bf16_f32 v56, v56, v57
    v_cvt_pk_bf16_f32 v57, v58, v59
    buffer_store_dwordx2 v[56:57], v119, s[4:7], s36 offen
    s_add_u32 s36, s36, 32768
    v_pk_mul_f32 v[60:61], v[60:61], v[104:105]
    v_pk_mul_f32 v[62:63], v[62:63], v[104:105]
    v_cvt_pk_bf16_f32 v60, v60, v61
    v_cvt_pk_bf16_f32 v61, v62, v63
    buffer_store_dwordx2 v[60:61], v119, s[4:7], s36 offen
    s_add_u32 s36, s36, 32768
    s_branch L_k1_fin
L_k1_v:
    v_mov_b32 v0, 0
    v_mov_b32 v1, 0
    v_mov_b32 v2, 0
    v_mov_b32 v3, 0
    v_mov_b32 v4, 0
    v_mov_b32 v5, 0
    v_mov_b32 v6, 0
    v_mov_b32 v7, 0
    v_mov_b32 v8, 0
    v_mov_b32 v9, 0
    v_mov_b32 v10, 0
    v_mov_b32 v11, 0
    v_mov_b32 v12, 0
    v_mov_b32 v13, 0
    v_mov_b32 v14, 0
    v_mov_b32 v15, 0
    v_mov_b32 v16, 0
    v_mov_b32 v17, 0
    v_mov_b32 v18, 0
    v_mov_b32 v19, 0
    v_mov_b32 v20, 0
    v_mov_b32 v21, 0
    v_mov_b32 v22, 0
    v_mov_b32 v23, 0
    v_mov_b32 v24, 0
    v_mov_b32 v25, 0
    v_mov_b32 v26, 0
    v_mov_b32 v27, 0
    v_mov_b32 v28, 0
    v_mov_b32 v29, 0
    v_mov_b32 v30, 0
    v_mov_b32 v31, 0
    v_mov_b32 v32, 0
    v_mov_b32 v33, 0
    v_mov_b32 v34, 0
    v_mov_b32 v35, 0
    v_mov_b32 v36, 0
    v_mov_b32 v37, 0
    v_mov_b32 v38, 0
    v_mov_b32 v39, 0
    v_mov_b32 v40, 0
    v_mov_b32 v41, 0
    v_mov_b32 v42, 0
    v_mov_b32 v43, 0
    v_mov_b32 v44, 0
    v_mov_b32 v45, 0
    v_mov_b32 v46, 0
    v_mov_b32 v47, 0
    v_mov_b32 v48, 0
    v_mov_b32 v49, 0
    v_mov_b32 v50, 0
    v_mov_b32 v51, 0
    v_mov_b32 v52, 0
    v_mov_b32 v53, 0
    v_mov_b32 v54, 0
    v_mov_b32 v55, 0
    v_mov_b32 v56, 0
    v_mov_b32 v57, 0
    v_mov_b32 v58, 0
    v_mov_b32 v59, 0
    v_mov_b32 v60, 0
    v_mov_b32 v61, 0
    v_mov_b32 v62, 0
    v_mov_b32 v63, 0
    v_mov_b32 v119, 160064
    s_mov_b32 s36, 1000000
L_k1_poll_v:
    ds_read_b32 v120, v119
    s_waitcnt lgkmcnt(0)
    v_readfirstlane_b32 s37, v120
    s_cmp_ge_u32 s37, 4
    s_cbranch_scc1 L_k1_go_v
    s_sub_u32 s36, s36, 1
    s_cmp_eq_u32 s36, 0
    s_cbranch_scc1 L_k1_go_v
    s_sleep 1
    s_branch L_k1_poll_v
L_k1_go_v:
    ds_read_b128 v[64:67], v104 offset:0
    ds_read_b64_tr_b16 v[72:73], v108 offset:0
    ds_read_b64_tr_b16 v[74:75], v108 offset:1024
    ds_read_b64_tr_b16 v[76:77], v109 offset:0
    ds_read_b64_tr_b16 v[78:79], v109 offset:1024
    ds_read_b64_tr_b16 v[80:81], v110 offset:0
    ds_read_b64_tr_b16 v[82:83], v110 offset:1024
    ds_read_b64_tr_b16 v[84:85], v111 offset:0
    ds_read_b64_tr_b16 v[86:87], v111 offset:1024
    s_waitcnt lgkmcnt(0)
    v_mfma_f32_32x32x16_bf16 v[0:15], v[64:67], v[72:75], v[0:15]
    ds_read_b128 v[68:71], v105 offset:0
    ds_read_b64_tr_b16 v[88:89], v108 offset:4096
    ds_read_b64_tr_b16 v[90:91], v108 offset:5120
    v_mfma_f32_32x32x16_bf16 v[16:31], v[64:67], v[76:79], v[16:31]
    ds_read_b64_tr_b16 v[92:93], v109 offset:4096
    ds_read_b64_tr_b16 v[94:95], v109 offset:5120
    ds_read_b64_tr_b16 v[96:97], v110 offset:4096
    v_mfma_f32_32x32x16_bf16 v[32:47], v[64:67], v[80:83], v[32:47]
    ds_read_b64_tr_b16 v[98:99], v110 offset:5120
    ds_read_b64_tr_b16 v[100:101], v111 offset:4096
    ds_read_b64_tr_b16 v[102:103], v111 offset:5120
    v_mfma_f32_32x32x16_bf16 v[48:63], v[64:67], v[84:87], v[48:63]
    s_waitcnt lgkmcnt(0)
    v_mfma_f32_32x32x16_bf16 v[0:15], v[68:71], v[88:91], v[0:15]
    ds_read_b128 v[64:67], v106 offset:0
    ds_read_b64_tr_b16 v[72:73], v108 offset:8192
    ds_read_b64_tr_b16 v[74:75], v108 offset:9216
    v_mfma_f32_32x32x16_bf16 v[16:31], v[68:71], v[92:95], v[16:31]
    ds_read_b64_tr_b16 v[76:77], v109 offset:8192
    ds_read_b64_tr_b16 v[78:79], v109 offset:9216
    ds_read_b64_tr_b16 v[80:81], v110 offset:8192
    v_mfma_f32_32x32x16_bf16 v[32:47], v[68:71], v[96:99], v[32:47]
    ds_read_b64_tr_b16 v[82:83], v110 offset:9216
    ds_read_b64_tr_b16 v[84:85], v111 offset:8192
    ds_read_b64_tr_b16 v[86:87], v111 offset:9216
    v_mfma_f32_32x32x16_bf16 v[48:63], v[68:71], v[100:103], v[48:63]
    s_waitcnt lgkmcnt(0)
    v_mfma_f32_32x32x16_bf16 v[0:15], v[64:67], v[72:75], v[0:15]
    ds_read_b128 v[68:71], v107 offset:0
    ds_read_b64_tr_b16 v[88:89], v108 offset:12288
    ds_read_b64_tr_b16 v[90:91], v108 offset:13312
    v_mfma_f32_32x32x16_bf16 v[16:31], v[64:67], v[76:79], v[16:31]
    ds_read_b64_tr_b16 v[92:93], v109 offset:12288
    ds_read_b64_tr_b16 v[94:95], v109 offset:13312
    ds_read_b64_tr_b16 v[96:97], v110 offset:12288
    v_mfma_f32_32x32x16_bf16 v[32:47], v[64:67], v[80:83], v[32:47]
    ds_read_b64_tr_b16 v[98:99], v110 offset:13312
    ds_read_b64_tr_b16 v[100:101], v111 offset:12288
    ds_read_b64_tr_b16 v[102:103], v111 offset:13312
    v_mfma_f32_32x32x16_bf16 v[48:63], v[64:67], v[84:87], v[48:63]
    s_waitcnt lgkmcnt(0)
    v_mfma_f32_32x32x16_bf16 v[0:15], v[68:71], v[88:91], v[0:15]
    v_mfma_f32_32x32x16_bf16 v[16:31], v[68:71], v[92:95], v[16:31]
    v_mfma_f32_32x32x16_bf16 v[32:47], v[68:71], v[96:99], v[32:47]
    v_mfma_f32_32x32x16_bf16 v[48:63], v[68:71], v[100:103], v[48:63]
    s_barrier
    ds_read_b128 v[64:67], v104 offset:16384
    ds_read_b64_tr_b16 v[72:73], v108 offset:16384
    ds_read_b64_tr_b16 v[74:75], v108 offset:17408
    ds_read_b64_tr_b16 v[76:77], v109 offset:16384
    ds_read_b64_tr_b16 v[78:79], v109 offset:17408
    ds_read_b64_tr_b16 v[80:81], v110 offset:16384
    ds_read_b64_tr_b16 v[82:83], v110 offset:17408
    ds_read_b64_tr_b16 v[84:85], v111 offset:16384
    ds_read_b64_tr_b16 v[86:87], v111 offset:17408
    s_waitcnt lgkmcnt(0)
    v_mfma_f32_32x32x16_bf16 v[0:15], v[64:67], v[72:75], v[0:15]
    ds_read_b128 v[68:71], v105 offset:16384
    ds_read_b64_tr_b16 v[88:89], v108 offset:20480
    ds_read_b64_tr_b16 v[90:91], v108 offset:21504
    v_mfma_f32_32x32x16_bf16 v[16:31], v[64:67], v[76:79], v[16:31]
    ds_read_b64_tr_b16 v[92:93], v109 offset:20480
    ds_read_b64_tr_b16 v[94:95], v109 offset:21504
    ds_read_b64_tr_b16 v[96:97], v110 offset:20480
    v_mfma_f32_32x32x16_bf16 v[32:47], v[64:67], v[80:83], v[32:47]
    ds_read_b64_tr_b16 v[98:99], v110 offset:21504
    ds_read_b64_tr_b16 v[100:101], v111 offset:20480
    ds_read_b64_tr_b16 v[102:103], v111 offset:21504
    v_mfma_f32_32x32x16_bf16 v[48:63], v[64:67], v[84:87], v[48:63]
    s_waitcnt lgkmcnt(0)
    v_mfma_f32_32x32x16_bf16 v[0:15], v[68:71], v[88:91], v[0:15]
    ds_read_b128 v[64:67], v106 offset:16384
    ds_read_b64_tr_b16 v[72:73], v108 offset:24576
    ds_read_b64_tr_b16 v[74:75], v108 offset:25600
    v_mfma_f32_32x32x16_bf16 v[16:31], v[68:71], v[92:95], v[16:31]
    ds_read_b64_tr_b16 v[76:77], v109 offset:24576
    ds_read_b64_tr_b16 v[78:79], v109 offset:25600
    ds_read_b64_tr_b16 v[80:81], v110 offset:24576
    v_mfma_f32_32x32x16_bf16 v[32:47], v[68:71], v[96:99], v[32:47]
    ds_read_b64_tr_b16 v[82:83], v110 offset:25600
    ds_read_b64_tr_b16 v[84:85], v111 offset:24576
    ds_read_b64_tr_b16 v[86:87], v111 offset:25600
    v_mfma_f32_32x32x16_bf16 v[48:63], v[68:71], v[100:103], v[48:63]
    s_waitcnt lgkmcnt(0)
    v_mfma_f32_32x32x16_bf16 v[0:15], v[64:67], v[72:75], v[0:15]
    ds_read_b128 v[68:71], v107 offset:16384
    ds_read_b64_tr_b16 v[88:89], v108 offset:28672
    ds_read_b64_tr_b16 v[90:91], v108 offset:29696
    v_mfma_f32_32x32x16_bf16 v[16:31], v[64:67], v[76:79], v[16:31]
    ds_read_b64_tr_b16 v[92:93], v109 offset:28672
    ds_read_b64_tr_b16 v[94:95], v109 offset:29696
    ds_read_b64_tr_b16 v[96:97], v110 offset:28672
    v_mfma_f32_32x32x16_bf16 v[32:47], v[64:67], v[80:83], v[32:47]
    ds_read_b64_tr_b16 v[98:99], v110 offset:29696
    ds_read_b64_tr_b16 v[100:101], v111 offset:28672
    ds_read_b64_tr_b16 v[102:103], v111 offset:29696
    v_mfma_f32_32x32x16_bf16 v[48:63], v[64:67], v[84:87], v[48:63]
    s_waitcnt lgkmcnt(0)
    v_mfma_f32_32x32x16_bf16 v[0:15], v[68:71], v[88:91], v[0:15]
    ds_read_b128 v[64:67], v104 offset:32768
    ds_read_b64_tr_b16 v[72:73], v108 offset:32768
    ds_read_b64_tr_b16 v[74:75], v108 offset:33792
    v_mfma_f32_32x32x16_bf16 v[16:31], v[68:71], v[92:95], v[16:31]
    ds_read_b64_tr_b16 v[76:77], v109 offset:32768
    ds_read_b64_tr_b16 v[78:79], v109 offset:33792
    ds_read_b64_tr_b16 v[80:81], v110 offset:32768
    v_mfma_f32_32x32x16_bf16 v[32:47], v[68:71], v[96:99], v[32:47]
    ds_read_b64_tr_b16 v[82:83], v110 offset:33792
    ds_read_b64_tr_b16 v[84:85], v111 offset:32768
    ds_read_b64_tr_b16 v[86:87], v111 offset:33792
    v_mfma_f32_32x32x16_bf16 v[48:63], v[68:71], v[100:103], v[48:63]
    s_barrier
    s_waitcnt lgkmcnt(0)
    v_mfma_f32_32x32x16_bf16 v[0:15], v[64:67], v[72:75], v[0:15]
    ds_read_b128 v[68:71], v105 offset:32768
    ds_read_b64_tr_b16 v[88:89], v108 offset:36864
    ds_read_b64_tr_b16 v[90:91], v108 offset:37888
    v_mfma_f32_32x32x16_bf16 v[16:31], v[64:67], v[76:79], v[16:31]
    ds_read_b64_tr_b16 v[92:93], v109 offset:36864
    ds_read_b64_tr_b16 v[94:95], v109 offset:37888
    ds_read_b64_tr_b16 v[96:97], v110 offset:36864
    v_mfma_f32_32x32x16_bf16 v[32:47], v[64:67], v[80:83], v[32:47]
    ds_read_b64_tr_b16 v[98:99], v110 offset:37888
    ds_read_b64_tr_b16 v[100:101], v111 offset:36864
    ds_read_b64_tr_b16 v[102:103], v111 offset:37888
    v_mfma_f32_32x32x16_bf16 v[48:63], v[64:67], v[84:87], v[48:63]
    s_waitcnt lgkmcnt(0)
    v_mfma_f32_32x32x16_bf16 v[0:15], v[68:71], v[88:91], v[0:15]
    ds_read_b128 v[64:67], v106 offset:32768
    ds_read_b64_tr_b16 v[72:73], v108 offset:40960
    ds_read_b64_tr_b16 v[74:75], v108 offset:41984
    v_mfma_f32_32x32x16_bf16 v[16:31], v[68:71], v[92:95], v[16:31]
    ds_read_b64_tr_b16 v[76:77], v109 offset:40960
    ds_read_b64_tr_b16 v[78:79], v109 offset:41984
    ds_read_b64_tr_b16 v[80:81], v110 offset:40960
    v_mfma_f32_32x32x16_bf16 v[32:47], v[68:71], v[96:99], v[32:47]
    ds_read_b64_tr_b16 v[82:83], v110 offset:41984
    ds_read_b64_tr_b16 v[84:85], v111 offset:40960
    ds_read_b64_tr_b16 v[86:87], v111 offset:41984
    v_mfma_f32_32x32x16_bf16 v[48:63], v[68:71], v[100:103], v[48:63]
    s_waitcnt lgkmcnt(0)
    v_mfma_f32_32x32x16_bf16 v[0:15], v[64:67], v[72:75], v[0:15]
    ds_read_b128 v[68:71], v107 offset:32768
    ds_read_b64_tr_b16 v[88:89], v108 offset:45056
    ds_read_b64_tr_b16 v[90:91], v108 offset:46080
    v_mfma_f32_32x32x16_bf16 v[16:31], v[64:67], v[76:79], v[16:31]
    ds_read_b64_tr_b16 v[92:93], v109 offset:45056
    ds_read_b64_tr_b16 v[94:95], v109 offset:46080
    ds_read_b64_tr_b16 v[96:97], v110 offset:45056
    v_mfma_f32_32x32x16_bf16 v[32:47], v[64:67], v[80:83], v[32:47]
    ds_read_b64_tr_b16 v[98:99], v110 offset:46080
    ds_read_b64_tr_b16 v[100:101], v111 offset:45056
    ds_read_b64_tr_b16 v[102:103], v111 offset:46080
    v_mfma_f32_32x32x16_bf16 v[48:63], v[64:67], v[84:87], v[48:63]
    s_waitcnt lgkmcnt(0)
    v_mfma_f32_32x32x16_bf16 v[0:15], v[68:71], v[88:91], v[0:15]
    ds_read_b128 v[64:67], v104 offset:49152
    ds_read_b64_tr_b16 v[72:73], v108 offset:49152
    ds_read_b64_tr_b16 v[74:75], v108 offset:50176
    v_mfma_f32_32x32x16_bf16 v[16:31], v[68:71], v[92:95], v[16:31]
    ds_read_b64_tr_b16 v[76:77], v109 offset:49152
    ds_read_b64_tr_b16 v[78:79], v109 offset:50176
    ds_read_b64_tr_b16 v[80:81], v110 offset:49152
    v_mfma_f32_32x32x16_bf16 v[32:47], v[68:71], v[96:99], v[32:47]
    ds_read_b64_tr_b16 v[82:83], v110 offset:50176
    ds_read_b64_tr_b16 v[84:85], v111 offset:49152
    ds_read_b64_tr_b16 v[86:87], v111 offset:50176
    v_mfma_f32_32x32x16_bf16 v[48:63], v[68:71], v[100:103], v[48:63]
    s_barrier
    s_waitcnt lgkmcnt(0)
    v_mfma_f32_32x32x16_bf16 v[0:15], v[64:67], v[72:75], v[0:15]
    ds_read_b128 v[68:71], v105 offset:49152
    ds_read_b64_tr_b16 v[88:89], v108 offset:0
    ds_read_b64_tr_b16 v[90:91], v108 offset:1024
    v_mfma_f32_32x32x16_bf16 v[16:31], v[64:67], v[76:79], v[16:31]
    ds_read_b64_tr_b16 v[92:93], v109 offset:0
    ds_read_b64_tr_b16 v[94:95], v109 offset:1024
    ds_read_b64_tr_b16 v[96:97], v110 offset:0
    v_mfma_f32_32x32x16_bf16 v[32:47], v[64:67], v[80:83], v[32:47]
    ds_read_b64_tr_b16 v[98:99], v110 offset:1024
    ds_read_b64_tr_b16 v[100:101], v111 offset:0
    ds_read_b64_tr_b16 v[102:103], v111 offset:1024
    v_mfma_f32_32x32x16_bf16 v[48:63], v[64:67], v[84:87], v[48:63]
    s_waitcnt lgkmcnt(0)
    v_mfma_f32_32x32x16_bf16 v[0:15], v[68:71], v[88:91], v[0:15]
    ds_read_b128 v[64:67], v106 offset:49152
    ds_read_b64_tr_b16 v[72:73], v108 offset:4096
    ds_read_b64_tr_b16 v[74:75], v108 offset:5120
    v_mfma_f32_32x32x16_bf16 v[16:31], v[68:71], v[92:95], v[16:31]
    ds_read_b64_tr_b16 v[76:77], v109 offset:4096
    ds_read_b64_tr_b16 v[78:79], v109 offset:5120
    ds_read_b64_tr_b16 v[80:81], v110 offset:4096
    v_mfma_f32_32x32x16_bf16 v[32:47], v[68:71], v[96:99], v[32:47]
    ds_read_b64_tr_b16 v[82:83], v110 offset:5120
    ds_read_b64_tr_b16 v[84:85], v111 offset:4096
    ds_read_b64_tr_b16 v[86:87], v111 offset:5120
    v_mfma_f32_32x32x16_bf16 v[48:63], v[68:71], v[100:103], v[48:63]
    s_waitcnt lgkmcnt(0)
    v_mfma_f32_32x32x16_bf16 v[0:15], v[64:67], v[72:75], v[0:15]
    ds_read_b128 v[68:71], v107 offset:49152
    ds_read_b64_tr_b16 v[88:89], v108 offset:8192
    ds_read_b64_tr_b16 v[90:91], v108 offset:9216
    v_mfma_f32_32x32x16_bf16 v[16:31], v[64:67], v[76:79], v[16:31]
    ds_read_b64_tr_b16 v[92:93], v109 offset:8192
    ds_read_b64_tr_b16 v[94:95], v109 offset:9216
    ds_read_b64_tr_b16 v[96:97], v110 offset:8192
    v_mfma_f32_32x32x16_bf16 v[32:47], v[64:67], v[80:83], v[32:47]
    ds_read_b64_tr_b16 v[98:99], v110 offset:9216
    ds_read_b64_tr_b16 v[100:101], v111 offset:8192
    ds_read_b64_tr_b16 v[102:103], v111 offset:9216
    v_mfma_f32_32x32x16_bf16 v[48:63], v[64:67], v[84:87], v[48:63]
    s_waitcnt lgkmcnt(0)
    v_mfma_f32_32x32x16_bf16 v[0:15], v[68:71], v[88:91], v[0:15]
    ds_read_b128 v[64:67], v104 offset:0
    ds_read_b64_tr_b16 v[72:73], v108 offset:12288
    ds_read_b64_tr_b16 v[74:75], v108 offset:13312
    v_mfma_f32_32x32x16_bf16 v[16:31], v[68:71], v[92:95], v[16:31]
    ds_read_b64_tr_b16 v[76:77], v109 offset:12288
    ds_read_b64_tr_b16 v[78:79], v109 offset:13312
    ds_read_b64_tr_b16 v[80:81], v110 offset:12288
    v_mfma_f32_32x32x16_bf16 v[32:47], v[68:71], v[96:99], v[32:47]
    ds_read_b64_tr_b16 v[82:83], v110 offset:13312
    ds_read_b64_tr_b16 v[84:85], v111 offset:12288
    ds_read_b64_tr_b16 v[86:87], v111 offset:13312
    v_mfma_f32_32x32x16_bf16 v[48:63], v[68:71], v[100:103], v[48:63]
    s_barrier
    s_waitcnt lgkmcnt(0)
    v_mfma_f32_32x32x16_bf16 v[0:15], v[64:67], v[72:75], v[0:15]
    ds_read_b128 v[68:71], v105 offset:0
    ds_read_b64_tr_b16 v[88:89], v108 offset:16384
    ds_read_b64_tr_b16 v[90:91], v108 offset:17408
    v_mfma_f32_32x32x16_bf16 v[16:31], v[64:67], v[76:79], v[16:31]
    ds_read_b64_tr_b16 v[92:93], v109 offset:16384
    ds_read_b64_tr_b16 v[94:95], v109 offset:17408
    ds_read_b64_tr_b16 v[96:97], v110 offset:16384
    v_mfma_f32_32x32x16_bf16 v[32:47], v[64:67], v[80:83], v[32:47]
    ds_read_b64_tr_b16 v[98:99], v110 offset:17408
    ds_read_b64_tr_b16 v[100:101], v111 offset:16384
    ds_read_b64_tr_b16 v[102:103], v111 offset:17408
    v_mfma_f32_32x32x16_bf16 v[48:63], v[64:67], v[84:87], v[48:63]
    s_waitcnt lgkmcnt(0)
    v_mfma_f32_32x32x16_bf16 v[0:15], v[68:71], v[88:91], v[0:15]
    ds_read_b128 v[64:67], v106 offset:0
    ds_read_b64_tr_b16 v[72:73], v108 offset:20480
    ds_read_b64_tr_b16 v[74:75], v108 offset:21504
    v_mfma_f32_32x32x16_bf16 v[16:31], v[68:71], v[92:95], v[16:31]
    ds_read_b64_tr_b16 v[76:77], v109 offset:20480
    ds_read_b64_tr_b16 v[78:79], v109 offset:21504
    ds_read_b64_tr_b16 v[80:81], v110 offset:20480
    v_mfma_f32_32x32x16_bf16 v[32:47], v[68:71], v[96:99], v[32:47]
    ds_read_b64_tr_b16 v[82:83], v110 offset:21504
    ds_read_b64_tr_b16 v[84:85], v111 offset:20480
    ds_read_b64_tr_b16 v[86:87], v111 offset:21504
    v_mfma_f32_32x32x16_bf16 v[48:63], v[68:71], v[100:103], v[48:63]
    s_waitcnt lgkmcnt(0)
    v_mfma_f32_32x32x16_bf16 v[0:15], v[64:67], v[72:75], v[0:15]
    ds_read_b128 v[68:71], v107 offset:0
    ds_read_b64_tr_b16 v[88:89], v108 offset:24576
    ds_read_b64_tr_b16 v[90:91], v108 offset:25600
    v_mfma_f32_32x32x16_bf16 v[16:31], v[64:67], v[76:79], v[16:31]
    ds_read_b64_tr_b16 v[92:93], v109 offset:24576
    ds_read_b64_tr_b16 v[94:95], v109 offset:25600
    ds_read_b64_tr_b16 v[96:97], v110 offset:24576
    v_mfma_f32_32x32x16_bf16 v[32:47], v[64:67], v[80:83], v[32:47]
    ds_read_b64_tr_b16 v[98:99], v110 offset:25600
    ds_read_b64_tr_b16 v[100:101], v111 offset:24576
    ds_read_b64_tr_b16 v[102:103], v111 offset:25600
    v_mfma_f32_32x32x16_bf16 v[48:63], v[64:67], v[84:87], v[48:63]
    s_waitcnt lgkmcnt(0)
    v_mfma_f32_32x32x16_bf16 v[0:15], v[68:71], v[88:91], v[0:15]
    ds_read_b128 v[64:67], v104 offset:16384
    ds_read_b64_tr_b16 v[72:73], v108 offset:28672
    ds_read_b64_tr_b16 v[74:75], v108 offset:29696
    v_mfma_f32_32x32x16_bf16 v[16:31], v[68:71], v[92:95], v[16:31]
    ds_read_b64_tr_b16 v[76:77], v109 offset:28672
    ds_read_b64_tr_b16 v[78:79], v109 offset:29696
    ds_read_b64_tr_b16 v[80:81], v110 offset:28672
    v_mfma_f32_32x32x16_bf16 v[32:47], v[68:71], v[96:99], v[32:47]
    ds_read_b64_tr_b16 v[82:83], v110 offset:29696
    ds_read_b64_tr_b16 v[84:85], v111 offset:28672
    ds_read_b64_tr_b16 v[86:87], v111 offset:29696
    v_mfma_f32_32x32x16_bf16 v[48:63], v[68:71], v[100:103], v[48:63]
    s_barrier
    s_waitcnt lgkmcnt(0)
    v_mfma_f32_32x32x16_bf16 v[0:15], v[64:67], v[72:75], v[0:15]
    ds_read_b128 v[68:71], v105 offset:16384
    ds_read_b64_tr_b16 v[88:89], v108 offset:32768
    ds_read_b64_tr_b16 v[90:91], v108 offset:33792
    v_mfma_f32_32x32x16_bf16 v[16:31], v[64:67], v[76:79], v[16:31]
    ds_read_b64_tr_b16 v[92:93], v109 offset:32768
    ds_read_b64_tr_b16 v[94:95], v109 offset:33792
    ds_read_b64_tr_b16 v[96:97], v110 offset:32768
    v_mfma_f32_32x32x16_bf16 v[32:47], v[64:67], v[80:83], v[32:47]
    ds_read_b64_tr_b16 v[98:99], v110 offset:33792
    ds_read_b64_tr_b16 v[100:101], v111 offset:32768
    ds_read_b64_tr_b16 v[102:103], v111 offset:33792
    v_mfma_f32_32x32x16_bf16 v[48:63], v[64:67], v[84:87], v[48:63]
    s_waitcnt lgkmcnt(0)
    v_mfma_f32_32x32x16_bf16 v[0:15], v[68:71], v[88:91], v[0:15]
    ds_read_b128 v[64:67], v106 offset:16384
    ds_read_b64_tr_b16 v[72:73], v108 offset:36864
    ds_read_b64_tr_b16 v[74:75], v108 offset:37888
    v_mfma_f32_32x32x16_bf16 v[16:31], v[68:71], v[92:95], v[16:31]
    ds_read_b64_tr_b16 v[76:77], v109 offset:36864
    ds_read_b64_tr_b16 v[78:79], v109 offset:37888
    ds_read_b64_tr_b16 v[80:81], v110 offset:36864
    v_mfma_f32_32x32x16_bf16 v[32:47], v[68:71], v[96:99], v[32:47]
    ds_read_b64_tr_b16 v[82:83], v110 offset:37888
    ds_read_b64_tr_b16 v[84:85], v111 offset:36864
    ds_read_b64_tr_b16 v[86:87], v111 offset:37888
    v_mfma_f32_32x32x16_bf16 v[48:63], v[68:71], v[100:103], v[48:63]
    s_waitcnt lgkmcnt(0)
    v_mfma_f32_32x32x16_bf16 v[0:15], v[64:67], v[72:75], v[0:15]
    ds_read_b128 v[68:71], v107 offset:16384
    ds_read_b64_tr_b16 v[88:89], v108 offset:40960
    ds_read_b64_tr_b16 v[90:91], v108 offset:41984
    v_mfma_f32_32x32x16_bf16 v[16:31], v[64:67], v[76:79], v[16:31]
    ds_read_b64_tr_b16 v[92:93], v109 offset:40960
    ds_read_b64_tr_b16 v[94:95], v109 offset:41984
    ds_read_b64_tr_b16 v[96:97], v110 offset:40960
    v_mfma_f32_32x32x16_bf16 v[32:47], v[64:67], v[80:83], v[32:47]
    ds_read_b64_tr_b16 v[98:99], v110 offset:41984
    ds_read_b64_tr_b16 v[100:101], v111 offset:40960
    ds_read_b64_tr_b16 v[102:103], v111 offset:41984
    v_mfma_f32_32x32x16_bf16 v[48:63], v[64:67], v[84:87], v[48:63]
    s_waitcnt lgkmcnt(0)
    v_mfma_f32_32x32x16_bf16 v[0:15], v[68:71], v[88:91], v[0:15]
    ds_read_b128 v[64:67], v104 offset:32768
    ds_read_b64_tr_b16 v[72:73], v108 offset:45056
    ds_read_b64_tr_b16 v[74:75], v108 offset:46080
    v_mfma_f32_32x32x16_bf16 v[16:31], v[68:71], v[92:95], v[16:31]
    ds_read_b64_tr_b16 v[76:77], v109 offset:45056
    ds_read_b64_tr_b16 v[78:79], v109 offset:46080
    ds_read_b64_tr_b16 v[80:81], v110 offset:45056
    v_mfma_f32_32x32x16_bf16 v[32:47], v[68:71], v[96:99], v[32:47]
    ds_read_b64_tr_b16 v[82:83], v110 offset:46080
    ds_read_b64_tr_b16 v[84:85], v111 offset:45056
    ds_read_b64_tr_b16 v[86:87], v111 offset:46080
    v_mfma_f32_32x32x16_bf16 v[48:63], v[68:71], v[100:103], v[48:63]
    s_barrier
    s_waitcnt lgkmcnt(0)
    v_mfma_f32_32x32x16_bf16 v[0:15], v[64:67], v[72:75], v[0:15]
    ds_read_b128 v[68:71], v105 offset:32768
    ds_read_b64_tr_b16 v[88:89], v108 offset:49152
    ds_read_b64_tr_b16 v[90:91], v108 offset:50176
    v_mfma_f32_32x32x16_bf16 v[16:31], v[64:67], v[76:79], v[16:31]
    ds_read_b64_tr_b16 v[92:93], v109 offset:49152
    ds_read_b64_tr_b16 v[94:95], v109 offset:50176
    ds_read_b64_tr_b16 v[96:97], v110 offset:49152
    v_mfma_f32_32x32x16_bf16 v[32:47], v[64:67], v[80:83], v[32:47]
    ds_read_b64_tr_b16 v[98:99], v110 offset:50176
    ds_read_b64_tr_b16 v[100:101], v111 offset:49152
    ds_read_b64_tr_b16 v[102:103], v111 offset:50176
    v_mfma_f32_32x32x16_bf16 v[48:63], v[64:67], v[84:87], v[48:63]
    s_waitcnt lgkmcnt(0)
    v_mfma_f32_32x32x16_bf16 v[0:15], v[68:71], v[88:91], v[0:15]
    ds_read_b128 v[64:67], v106 offset:32768
    ds_read_b64_tr_b16 v[72:73], v108 offset:0
    ds_read_b64_tr_b16 v[74:75], v108 offset:1024
    v_mfma_f32_32x32x16_bf16 v[16:31], v[68:71], v[92:95], v[16:31]
    ds_read_b64_tr_b16 v[76:77], v109 offset:0
    ds_read_b64_tr_b16 v[78:79], v109 offset:1024
    ds_read_b64_tr_b16 v[80:81], v110 offset:0
    v_mfma_f32_32x32x16_bf16 v[32:47], v[68:71], v[96:99], v[32:47]
    ds_read_b64_tr_b16 v[82:83], v110 offset:1024
    ds_read_b64_tr_b16 v[84:85], v111 offset:0
    ds_read_b64_tr_b16 v[86:87], v111 offset:1024
    v_mfma_f32_32x32x16_bf16 v[48:63], v[68:71], v[100:103], v[48:63]
    s_waitcnt lgkmcnt(0)
    v_mfma_f32_32x32x16_bf16 v[0:15], v[64:67], v[72:75], v[0:15]
    ds_read_b128 v[68:71], v107 offset:32768
    ds_read_b64_tr_b16 v[88:89], v108 offset:4096
    ds_read_b64_tr_b16 v[90:91], v108 offset:5120
    v_mfma_f32_32x32x16_bf16 v[16:31], v[64:67], v[76:79], v[16:31]
    ds_read_b64_tr_b16 v[92:93], v109 offset:4096
    ds_read_b64_tr_b16 v[94:95], v109 offset:5120
    ds_read_b64_tr_b16 v[96:97], v110 offset:4096
    v_mfma_f32_32x32x16_bf16 v[32:47], v[64:67], v[80:83], v[32:47]
    ds_read_b64_tr_b16 v[98:99], v110 offset:5120
    ds_read_b64_tr_b16 v[100:101], v111 offset:4096
    ds_read_b64_tr_b16 v[102:103], v111 offset:5120
    v_mfma_f32_32x32x16_bf16 v[48:63], v[64:67], v[84:87], v[48:63]
    s_waitcnt lgkmcnt(0)
    v_mfma_f32_32x32x16_bf16 v[0:15], v[68:71], v[88:91], v[0:15]
    ds_read_b128 v[64:67], v104 offset:49152
    ds_read_b64_tr_b16 v[72:73], v108 offset:8192
    ds_read_b64_tr_b16 v[74:75], v108 offset:9216
    v_mfma_f32_32x32x16_bf16 v[16:31], v[68:71], v[92:95], v[16:31]
    ds_read_b64_tr_b16 v[76:77], v109 offset:8192
    ds_read_b64_tr_b16 v[78:79], v109 offset:9216
    ds_read_b64_tr_b16 v[80:81], v110 offset:8192
    v_mfma_f32_32x32x16_bf16 v[32:47], v[68:71], v[96:99], v[32:47]
    ds_read_b64_tr_b16 v[82:83], v110 offset:9216
    ds_read_b64_tr_b16 v[84:85], v111 offset:8192
    ds_read_b64_tr_b16 v[86:87], v111 offset:9216
    v_mfma_f32_32x32x16_bf16 v[48:63], v[68:71], v[100:103], v[48:63]
    s_barrier
    s_waitcnt lgkmcnt(0)
    v_mfma_f32_32x32x16_bf16 v[0:15], v[64:67], v[72:75], v[0:15]
    ds_read_b128 v[68:71], v105 offset:49152
    ds_read_b64_tr_b16 v[88:89], v108 offset:12288
    ds_read_b64_tr_b16 v[90:91], v108 offset:13312
    v_mfma_f32_32x32x16_bf16 v[16:31], v[64:67], v[76:79], v[16:31]
    ds_read_b64_tr_b16 v[92:93], v109 offset:12288
    ds_read_b64_tr_b16 v[94:95], v109 offset:13312
    ds_read_b64_tr_b16 v[96:97], v110 offset:12288
    v_mfma_f32_32x32x16_bf16 v[32:47], v[64:67], v[80:83], v[32:47]
    ds_read_b64_tr_b16 v[98:99], v110 offset:13312
    ds_read_b64_tr_b16 v[100:101], v111 offset:12288
    ds_read_b64_tr_b16 v[102:103], v111 offset:13312
    v_mfma_f32_32x32x16_bf16 v[48:63], v[64:67], v[84:87], v[48:63]
    s_waitcnt lgkmcnt(0)
    v_mfma_f32_32x32x16_bf16 v[0:15], v[68:71], v[88:91], v[0:15]
    ds_read_b128 v[64:67], v106 offset:49152
    ds_read_b64_tr_b16 v[72:73], v108 offset:16384
    ds_read_b64_tr_b16 v[74:75], v108 offset:17408
    v_mfma_f32_32x32x16_bf16 v[16:31], v[68:71], v[92:95], v[16:31]
    ds_read_b64_tr_b16 v[76:77], v109 offset:16384
    ds_read_b64_tr_b16 v[78:79], v109 offset:17408
    ds_read_b64_tr_b16 v[80:81], v110 offset:16384
    v_mfma_f32_32x32x16_bf16 v[32:47], v[68:71], v[96:99], v[32:47]
    ds_read_b64_tr_b16 v[82:83], v110 offset:17408
    ds_read_b64_tr_b16 v[84:85], v111 offset:16384
    ds_read_b64_tr_b16 v[86:87], v111 offset:17408
    v_mfma_f32_32x32x16_bf16 v[48:63], v[68:71], v[100:103], v[48:63]
    s_waitcnt lgkmcnt(0)
    v_mfma_f32_32x32x16_bf16 v[0:15], v[64:67], v[72:75], v[0:15]
    ds_read_b128 v[68:71], v107 offset:49152
    ds_read_b64_tr_b16 v[88:89], v108 offset:20480
    ds_read_b64_tr_b16 v[90:91], v108 offset:21504
    v_mfma_f32_32x32x16_bf16 v[16:31], v[64:67], v[76:79], v[16:31]
    ds_read_b64_tr_b16 v[92:93], v109 offset:20480
    ds_read_b64_tr_b16 v[94:95], v109 offset:21504
    ds_read_b64_tr_b16 v[96:97], v110 offset:20480
    v_mfma_f32_32x32x16_bf16 v[32:47], v[64:67], v[80:83], v[32:47]
    ds_read_b64_tr_b16 v[98:99], v110 offset:21504
    ds_read_b64_tr_b16 v[100:101], v111 offset:20480
    ds_read_b64_tr_b16 v[102:103], v111 offset:21504
    v_mfma_f32_32x32x16_bf16 v[48:63], v[64:67], v[84:87], v[48:63]
    s_waitcnt lgkmcnt(0)
    v_mfma_f32_32x32x16_bf16 v[0:15], v[68:71], v[88:91], v[0:15]
    ds_read_b128 v[64:67], v104 offset:0
    ds_read_b64_tr_b16 v[72:73], v108 offset:24576
    ds_read_b64_tr_b16 v[74:75], v108 offset:25600
    v_mfma_f32_32x32x16_bf16 v[16:31], v[68:71], v[92:95], v[16:31]
    ds_read_b64_tr_b16 v[76:77], v109 offset:24576
    ds_read_b64_tr_b16 v[78:79], v109 offset:25600
    ds_read_b64_tr_b16 v[80:81], v110 offset:24576
    v_mfma_f32_32x32x16_bf16 v[32:47], v[68:71], v[96:99], v[32:47]
    ds_read_b64_tr_b16 v[82:83], v110 offset:25600
    ds_read_b64_tr_b16 v[84:85], v111 offset:24576
    ds_read_b64_tr_b16 v[86:87], v111 offset:25600
    v_mfma_f32_32x32x16_bf16 v[48:63], v[68:71], v[100:103], v[48:63]
    s_barrier
    s_waitcnt lgkmcnt(0)
    v_mfma_f32_32x32x16_bf16 v[0:15], v[64:67], v[72:75], v[0:15]
    ds_read_b128 v[68:71], v105 offset:0
    ds_read_b64_tr_b16 v[88:89], v108 offset:28672
    ds_read_b64_tr_b16 v[90:91], v108 offset:29696
    v_mfma_f32_32x32x16_bf16 v[16:31], v[64:67], v[76:79], v[16:31]
    ds_read_b64_tr_b16 v[92:93], v109 offset:28672
    ds_read_b64_tr_b16 v[94:95], v109 offset:29696
    ds_read_b64_tr_b16 v[96:97], v110 offset:28672
    v_mfma_f32_32x32x16_bf16 v[32:47], v[64:67], v[80:83], v[32:47]
    ds_read_b64_tr_b16 v[98:99], v110 offset:29696
    ds_read_b64_tr_b16 v[100:101], v111 offset:28672
    ds_read_b64_tr_b16 v[102:103], v111 offset:29696
    v_mfma_f32_32x32x16_bf16 v[48:63], v[64:67], v[84:87], v[48:63]
    s_waitcnt lgkmcnt(0)
    v_mfma_f32_32x32x16_bf16 v[0:15], v[68:71], v[88:91], v[0:15]
    ds_read_b128 v[64:67], v106 offset:0
    ds_read_b64_tr_b16 v[72:73], v108 offset:32768
    ds_read_b64_tr_b16 v[74:75], v108 offset:33792
    v_mfma_f32_32x32x16_bf16 v[16:31], v[68:71], v[92:95], v[16:31]
    ds_read_b64_tr_b16 v[76:77], v109 offset:32768
    ds_read_b64_tr_b16 v[78:79], v109 offset:33792
    ds_read_b64_tr_b16 v[80:81], v110 offset:32768
    v_mfma_f32_32x32x16_bf16 v[32:47], v[68:71], v[96:99], v[32:47]
    ds_read_b64_tr_b16 v[82:83], v110 offset:33792
    ds_read_b64_tr_b16 v[84:85], v111 offset:32768
    ds_read_b64_tr_b16 v[86:87], v111 offset:33792
    v_mfma_f32_32x32x16_bf16 v[48:63], v[68:71], v[100:103], v[48:63]
    s_waitcnt lgkmcnt(0)
    v_mfma_f32_32x32x16_bf16 v[0:15], v[64:67], v[72:75], v[0:15]
    ds_read_b128 v[68:71], v107 offset:0
    ds_read_b64_tr_b16 v[88:89], v108 offset:36864
    ds_read_b64_tr_b16 v[90:91], v108 offset:37888
    v_mfma_f32_32x32x16_bf16 v[16:31], v[64:67], v[76:79], v[16:31]
    ds_read_b64_tr_b16 v[92:93], v109 offset:36864
    ds_read_b64_tr_b16 v[94:95], v109 offset:37888
    ds_read_b64_tr_b16 v[96:97], v110 offset:36864
    v_mfma_f32_32x32x16_bf16 v[32:47], v[64:67], v[80:83], v[32:47]
    ds_read_b64_tr_b16 v[98:99], v110 offset:37888
    ds_read_b64_tr_b16 v[100:101], v111 offset:36864
    ds_read_b64_tr_b16 v[102:103], v111 offset:37888
    v_mfma_f32_32x32x16_bf16 v[48:63], v[64:67], v[84:87], v[48:63]
    s_waitcnt lgkmcnt(0)
    v_mfma_f32_32x32x16_bf16 v[0:15], v[68:71], v[88:91], v[0:15]
    ds_read_b128 v[64:67], v104 offset:16384
    ds_read_b64_tr_b16 v[72:73], v108 offset:40960
    ds_read_b64_tr_b16 v[74:75], v108 offset:41984
    v_mfma_f32_32x32x16_bf16 v[16:31], v[68:71], v[92:95], v[16:31]
    ds_read_b64_tr_b16 v[76:77], v109 offset:40960
    ds_read_b64_tr_b16 v[78:79], v109 offset:41984
    ds_read_b64_tr_b16 v[80:81], v110 offset:40960
    v_mfma_f32_32x32x16_bf16 v[32:47], v[68:71], v[96:99], v[32:47]
    ds_read_b64_tr_b16 v[82:83], v110 offset:41984
    ds_read_b64_tr_b16 v[84:85], v111 offset:40960
    ds_read_b64_tr_b16 v[86:87], v111 offset:41984
    v_mfma_f32_32x32x16_bf16 v[48:63], v[68:71], v[100:103], v[48:63]
    s_barrier
    s_waitcnt lgkmcnt(0)
    v_mfma_f32_32x32x16_bf16 v[0:15], v[64:67], v[72:75], v[0:15]
    ds_read_b128 v[68:71], v105 offset:16384
    ds_read_b64_tr_b16 v[88:89], v108 offset:45056
    ds_read_b64_tr_b16 v[90:91], v108 offset:46080
    v_mfma_f32_32x32x16_bf16 v[16:31], v[64:67], v[76:79], v[16:31]
    ds_read_b64_tr_b16 v[92:93], v109 offset:45056
    ds_read_b64_tr_b16 v[94:95], v109 offset:46080
    ds_read_b64_tr_b16 v[96:97], v110 offset:45056
    v_mfma_f32_32x32x16_bf16 v[32:47], v[64:67], v[80:83], v[32:47]
    ds_read_b64_tr_b16 v[98:99], v110 offset:46080
    ds_read_b64_tr_b16 v[100:101], v111 offset:45056
    ds_read_b64_tr_b16 v[102:103], v111 offset:46080
    v_mfma_f32_32x32x16_bf16 v[48:63], v[64:67], v[84:87], v[48:63]
    s_waitcnt lgkmcnt(0)
    v_mfma_f32_32x32x16_bf16 v[0:15], v[68:71], v[88:91], v[0:15]
    ds_read_b128 v[64:67], v106 offset:16384
    ds_read_b64_tr_b16 v[72:73], v108 offset:49152
    ds_read_b64_tr_b16 v[74:75], v108 offset:50176
    v_mfma_f32_32x32x16_bf16 v[16:31], v[68:71], v[92:95], v[16:31]
    ds_read_b64_tr_b16 v[76:77], v109 offset:49152
    ds_read_b64_tr_b16 v[78:79], v109 offset:50176
    ds_read_b64_tr_b16 v[80:81], v110 offset:49152
    v_mfma_f32_32x32x16_bf16 v[32:47], v[68:71], v[96:99], v[32:47]
    ds_read_b64_tr_b16 v[82:83], v110 offset:50176
    ds_read_b64_tr_b16 v[84:85], v111 offset:49152
    ds_read_b64_tr_b16 v[86:87], v111 offset:50176
    v_mfma_f32_32x32x16_bf16 v[48:63], v[68:71], v[100:103], v[48:63]
    s_waitcnt lgkmcnt(0)
    v_mfma_f32_32x32x16_bf16 v[0:15], v[64:67], v[72:75], v[0:15]
    ds_read_b128 v[68:71], v107 offset:16384
    ds_read_b64_tr_b16 v[88:89], v108 offset:0
    ds_read_b64_tr_b16 v[90:91], v108 offset:1024
    v_mfma_f32_32x32x16_bf16 v[16:31], v[64:67], v[76:79], v[16:31]
    ds_read_b64_tr_b16 v[92:93], v109 offset:0
    ds_read_b64_tr_b16 v[94:95], v109 offset:1024
    ds_read_b64_tr_b16 v[96:97], v110 offset:0
    v_mfma_f32_32x32x16_bf16 v[32:47], v[64:67], v[80:83], v[32:47]
    ds_read_b64_tr_b16 v[98:99], v110 offset:1024
    ds_read_b64_tr_b16 v[100:101], v111 offset:0
    ds_read_b64_tr_b16 v[102:103], v111 offset:1024
    v_mfma_f32_32x32x16_bf16 v[48:63], v[64:67], v[84:87], v[48:63]
    s_waitcnt lgkmcnt(0)
    v_mfma_f32_32x32x16_bf16 v[0:15], v[68:71], v[88:91], v[0:15]
    v_mfma_f32_32x32x16_bf16 v[16:31], v[68:71], v[92:95], v[16:31]
    v_mfma_f32_32x32x16_bf16 v[32:47], v[68:71], v[96:99], v[32:47]
    v_mfma_f32_32x32x16_bf16 v[48:63], v[68:71], v[100:103], v[48:63]
    s_nop 15
    s_lshl_b32 s37, s26, 7
    s_sub_u32 s37, s37, 1280
    s_lshl_b32 s36, s25, 3
    s_lshl_b32 s39, s27, 1
    s_add_u32 s36, s36, s39
    s_mul_i32 s36, s36, 640
    s_add_u32 s36, s36, 5242880
    s_mov_b32 s38, 0x0ccccccd
    v_mul_u32_u24 v123, 320, v118
    s_add_u32 s39, s37, 0
    v_add_u32 v119, s39, v117
    v_mul_hi_u32 v120, v119, s38
    v_mul_u32_u24 v121, 20, v120
    v_sub_u32 v121, v119, v121
    v_mul_u32_u24 v120, 0x14000, v120
    v_lshl_add_u32 v120, v121, 4, v120
    v_add_u32 v120, v120, v123
    v_cvt_pk_bf16_f32 v0, v0, v1
    v_cvt_pk_bf16_f32 v1, v2, v3
    v_cvt_pk_bf16_f32 v2, v4, v5
    v_cvt_pk_bf16_f32 v3, v6, v7
    buffer_store_dwordx4 v[0:3], v120, s[4:7], s36 offen offset:0
    v_cvt_pk_bf16_f32 v8, v8, v9
    v_cvt_pk_bf16_f32 v9, v10, v11
    v_cvt_pk_bf16_f32 v10, v12, v13
    v_cvt_pk_bf16_f32 v11, v14, v15
    buffer_store_dwordx4 v[8:11], v120, s[4:7], s36 offen offset:640
    s_add_u32 s39, s37, 32
    v_add_u32 v119, s39, v117
    v_mul_hi_u32 v120, v119, s38
    v_mul_u32_u24 v121, 20, v120
    v_sub_u32 v121, v119, v121
    v_mul_u32_u24 v120, 0x14000, v120
    v_lshl_add_u32 v120, v121, 4, v120
    v_add_u32 v120, v120, v123
    v_cvt_pk_bf16_f32 v16, v16, v17
    v_cvt_pk_bf16_f32 v17, v18, v19
    v_cvt_pk_bf16_f32 v18, v20, v21
    v_cvt_pk_bf16_f32 v19, v22, v23
    buffer_store_dwordx4 v[16:19], v120, s[4:7], s36 offen offset:0
    v_cvt_pk_bf16_f32 v24, v24, v25
    v_cvt_pk_bf16_f32 v25, v26, v27
    v_cvt_pk_bf16_f32 v26, v28, v29
    v_cvt_pk_bf16_f32 v27, v30, v31
    buffer_store_dwordx4 v[24:27], v120, s[4:7], s36 offen offset:640
    s_add_u32 s39, s37, 64
    v_add_u32 v119, s39, v117
    v_mul_hi_u32 v120, v119, s38
    v_mul_u32_u24 v121, 20, v120
    v_sub_u32 v121, v119, v121
    v_mul_u32_u24 v120, 0x14000, v120
    v_lshl_add_u32 v120, v121, 4, v120
    v_add_u32 v120, v120, v123
    v_cvt_pk_bf16_f32 v32, v32, v33
    v_cvt_pk_bf16_f32 v33, v34, v35
    v_cvt_pk_bf16_f32 v34, v36, v37
    v_cvt_pk_bf16_f32 v35, v38, v39
    buffer_store_dwordx4 v[32:35], v120, s[4:7], s36 offen offset:0
    v_cvt_pk_bf16_f32 v40, v40, v41
    v_cvt_pk_bf16_f32 v41, v42, v43
    v_cvt_pk_bf16_f32 v42, v44, v45
    v_cvt_pk_bf16_f32 v43, v46, v47
    buffer_store_dwordx4 v[40:43], v120, s[4:7], s36 offen offset:640
    s_add_u32 s39, s37, 96
    v_add_u32 v119, s39, v117
    v_mul_hi_u32 v120, v119, s38
    v_mul_u32_u24 v121, 20, v120
    v_sub_u32 v121, v119, v121
    v_mul_u32_u24 v120, 0x14000, v120
    v_lshl_add_u32 v120, v121, 4, v120
    v_add_u32 v120, v120, v123
    v_cvt_pk_bf16_f32 v48, v48, v49
    v_cvt_pk_bf16_f32 v49, v50, v51
    v_cvt_pk_bf16_f32 v50, v52, v53
    v_cvt_pk_bf16_f32 v51, v54, v55
    buffer_store_dwordx4 v[48:51], v120, s[4:7], s36 offen offset:0
    v_cvt_pk_bf16_f32 v56, v56, v57
    v_cvt_pk_bf16_f32 v57, v58, v59
    v_cvt_pk_bf16_f32 v58, v60, v61
    v_cvt_pk_bf16_f32 v59, v62, v63
    buffer_store_dwordx4 v[56:59], v120, s[4:7], s36 offen offset:640
    s_branch L_k1_fin
L_k1_gate:
    v_lshlrev_b32 v108, 4, v118
    v_add_u32 v108, 158720, v108
    v_mov_b32 v0, 0
    v_mov_b32 v1, 0
    v_mov_b32 v2, 0
    v_mov_b32 v3, 0
    v_mov_b32 v4, 0
    v_mov_b32 v5, 0
    v_mov_b32 v6, 0
    v_mov_b32 v7, 0
    v_mov_b32 v8, 0
    v_mov_b32 v9, 0
    v_mov_b32 v10, 0
    v_mov_b32 v11, 0
    v_mov_b32 v12, 0
    v_mov_b32 v13, 0
    v_mov_b32 v14, 0
    v_mov_b32 v15, 0
    v_mov_b32 v119, 160064
    s_mov_b32 s36, 1000000
L_k1_poll_gate:
    ds_read_b32 v120, v119
    s_waitcnt lgkmcnt(0)
    v_readfirstlane_b32 s37, v120
    s_cmp_ge_u32 s37, 4
    s_cbranch_scc1 L_k1_go_gate
    s_sub_u32 s36, s36, 1
    s_cmp_eq_u32 s36, 0
    s_cbranch_scc1 L_k1_go_gate
    s_sleep 1
    s_branch L_k1_poll_gate
L_k1_go_gate:
    ds_read_b128 v[64:67], v104 offset:0
    ds_read_b128 v[72:75], v108 offset:0
    s_waitcnt lgkmcnt(0)
    v_mfma_f32_32x32x16_bf16 v[0:15], v[72:75], v[64:67], v[0:15]
    ds_read_b128 v[68:71], v105 offset:0
    ds_read_b128 v[88:91], v108 offset:32
    s_waitcnt lgkmcnt(0)
    v_mfma_f32_32x32x16_bf16 v[0:15], v[88:91], v[68:71], v[0:15]
    ds_read_b128 v[64:67], v106 offset:0
    ds_read_b128 v[72:75], v108 offset:64
    s_waitcnt lgkmcnt(0)
    v_mfma_f32_32x32x16_bf16 v[0:15], v[72:75], v[64:67], v[0:15]
    ds_read_b128 v[68:71], v107 offset:0
    ds_read_b128 v[88:91], v108 offset:96
    s_waitcnt lgkmcnt(0)
    v_mfma_f32_32x32x16_bf16 v[0:15], v[88:91], v[68:71], v[0:15]
    s_barrier
    ds_read_b128 v[64:67], v104 offset:16384
    ds_read_b128 v[72:75], v108 offset:128
    s_waitcnt lgkmcnt(0)
    v_mfma_f32_32x32x16_bf16 v[0:15], v[72:75], v[64:67], v[0:15]
    ds_read_b128 v[68:71], v105 offset:16384
    ds_read_b128 v[88:91], v108 offset:160
    s_waitcnt lgkmcnt(0)
    v_mfma_f32_32x32x16_bf16 v[0:15], v[88:91], v[68:71], v[0:15]
    ds_read_b128 v[64:67], v106 offset:16384
    ds_read_b128 v[72:75], v108 offset:192
    s_waitcnt lgkmcnt(0)
    v_mfma_f32_32x32x16_bf16 v[0:15], v[72:75], v[64:67], v[0:15]
    ds_read_b128 v[68:71], v107 offset:16384
    ds_read_b128 v[88:91], v108 offset:224
    s_waitcnt lgkmcnt(0)
    v_mfma_f32_32x32x16_bf16 v[0:15], v[88:91], v[68:71], v[0:15]
    ds_read_b128 v[64:67], v104 offset:32768
    ds_read_b128 v[72:75], v108 offset:256
    s_barrier
    s_waitcnt lgkmcnt(0)
    v_mfma_f32_32x32x16_bf16 v[0:15], v[72:75], v[64:67], v[0:15]
    ds_read_b128 v[68:71], v105 offset:32768
    ds_read_b128 v[88:91], v108 offset:288
    s_waitcnt lgkmcnt(0)
    v_mfma_f32_32x32x16_bf16 v[0:15], v[88:91], v[68:71], v[0:15]
    ds_read_b128 v[64:67], v106 offset:32768
    ds_read_b128 v[72:75], v108 offset:320
    s_waitcnt lgkmcnt(0)
    v_mfma_f32_32x32x16_bf16 v[0:15], v[72:75], v[64:67], v[0:15]
    ds_read_b128 v[68:71], v107 offset:32768
    ds_read_b128 v[88:91], v108 offset:352
    s_waitcnt lgkmcnt(0)
    v_mfma_f32_32x32x16_bf16 v[0:15], v[88:91], v[68:71], v[0:15]
    ds_read_b128 v[64:67], v104 offset:49152
    ds_read_b128 v[72:75], v108 offset:384
    s_barrier
    s_waitcnt lgkmcnt(0)
    v_mfma_f32_32x32x16_bf16 v[0:15], v[72:75], v[64:67], v[0:15]
    ds_read_b128 v[68:71], v105 offset:49152
    ds_read_b128 v[88:91], v108 offset:416
    s_waitcnt lgkmcnt(0)
    v_mfma_f32_32x32x16_bf16 v[0:15], v[88:91], v[68:71], v[0:15]
    ds_read_b128 v[64:67], v106 offset:49152
    ds_read_b128 v[72:75], v108 offset:448
    s_waitcnt lgkmcnt(0)
    v_mfma_f32_32x32x16_bf16 v[0:15], v[72:75], v[64:67], v[0:15]
    ds_read_b128 v[68:71], v107 offset:49152
    ds_read_b128 v[88:91], v108 offset:480
    s_waitcnt lgkmcnt(0)
    v_mfma_f32_32x32x16_bf16 v[0:15], v[88:91], v[68:71], v[0:15]
    ds_read_b128 v[64:67], v104 offset:0
    ds_read_b128 v[72:75], v108 offset:512
    s_barrier
    s_waitcnt lgkmcnt(0)
    v_mfma_f32_32x32x16_bf16 v[0:15], v[72:75], v[64:67], v[0:15]
    ds_read_b128 v[68:71], v105 offset:0
    ds_read_b128 v[88:91], v108 offset:544
    s_waitcnt lgkmcnt(0)
    v_mfma_f32_32x32x16_bf16 v[0:15], v[88:91], v[68:71], v[0:15]
    ds_read_b128 v[64:67], v106 offset:0
    ds_read_b128 v[72:75], v108 offset:576
    s_waitcnt lgkmcnt(0)
    v_mfma_f32_32x32x16_bf16 v[0:15], v[72:75], v[64:67], v[0:15]
    ds_read_b128 v[68:71], v107 offset:0
    ds_read_b128 v[88:91], v108 offset:608
    s_waitcnt lgkmcnt(0)
    v_mfma_f32_32x32x16_bf16 v[0:15], v[88:91], v[68:71], v[0:15]
    ds_read_b128 v[64:67], v104 offset:16384
    ds_read_b128 v[72:75], v108 offset:640
    s_barrier
    s_waitcnt lgkmcnt(0)
    v_mfma_f32_32x32x16_bf16 v[0:15], v[72:75], v[64:67], v[0:15]
    ds_read_b128 v[68:71], v105 offset:16384
    ds_read_b128 v[88:91], v108 offset:672
    s_waitcnt lgkmcnt(0)
    v_mfma_f32_32x32x16_bf16 v[0:15], v[88:91], v[68:71], v[0:15]
    ds_read_b128 v[64:67], v106 offset:16384
    ds_read_b128 v[72:75], v108 offset:704
    s_waitcnt lgkmcnt(0)
    v_mfma_f32_32x32x16_bf16 v[0:15], v[72:75], v[64:67], v[0:15]
    ds_read_b128 v[68:71], v107 offset:16384
    ds_read_b128 v[88:91], v108 offset:736
    s_waitcnt lgkmcnt(0)
    v_mfma_f32_32x32x16_bf16 v[0:15], v[88:91], v[68:71], v[0:15]
    ds_read_b128 v[64:67], v104 offset:32768
    ds_read_b128 v[72:75], v108 offset:768
    s_barrier
    s_waitcnt lgkmcnt(0)
    v_mfma_f32_32x32x16_bf16 v[0:15], v[72:75], v[64:67], v[0:15]
    ds_read_b128 v[68:71], v105 offset:32768
    ds_read_b128 v[88:91], v108 offset:800
    s_waitcnt lgkmcnt(0)
    v_mfma_f32_32x32x16_bf16 v[0:15], v[88:91], v[68:71], v[0:15]
    ds_read_b128 v[64:67], v106 offset:32768
    ds_read_b128 v[72:75], v108 offset:832
    s_waitcnt lgkmcnt(0)
    v_mfma_f32_32x32x16_bf16 v[0:15], v[72:75], v[64:67], v[0:15]
    ds_read_b128 v[68:71], v107 offset:32768
    ds_read_b128 v[88:91], v108 offset:864
    s_waitcnt lgkmcnt(0)
    v_mfma_f32_32x32x16_bf16 v[0:15], v[88:91], v[68:71], v[0:15]
    ds_read_b128 v[64:67], v104 offset:49152
    ds_read_b128 v[72:75], v108 offset:896
    s_barrier
    s_waitcnt lgkmcnt(0)
    v_mfma_f32_32x32x16_bf16 v[0:15], v[72:75], v[64:67], v[0:15]
    ds_read_b128 v[68:71], v105 offset:49152
    ds_read_b128 v[88:91], v108 offset:928
    s_waitcnt lgkmcnt(0)
    v_mfma_f32_32x32x16_bf16 v[0:15], v[88:91], v[68:71], v[0:15]
    ds_read_b128 v[64:67], v106 offset:49152
    ds_read_b128 v[72:75], v108 offset:960
    s_waitcnt lgkmcnt(0)
    v_mfma_f32_32x32x16_bf16 v[0:15], v[72:75], v[64:67], v[0:15]
    ds_read_b128 v[68:71], v107 offset:49152
    ds_read_b128 v[88:91], v108 offset:992
    s_waitcnt lgkmcnt(0)
    v_mfma_f32_32x32x16_bf16 v[0:15], v[88:91], v[68:71], v[0:15]
    ds_read_b128 v[64:67], v104 offset:0
    ds_read_b128 v[72:75], v108 offset:1024
    s_barrier
    s_waitcnt lgkmcnt(0)
    v_mfma_f32_32x32x16_bf16 v[0:15], v[72:75], v[64:67], v[0:15]
    ds_read_b128 v[68:71], v105 offset:0
    ds_read_b128 v[88:91], v108 offset:1056
    s_waitcnt lgkmcnt(0)
    v_mfma_f32_32x32x16_bf16 v[0:15], v[88:91], v[68:71], v[0:15]
    ds_read_b128 v[64:67], v106 offset:0
    ds_read_b128 v[72:75], v108 offset:1088
    s_waitcnt lgkmcnt(0)
    v_mfma_f32_32x32x16_bf16 v[0:15], v[72:75], v[64:67], v[0:15]
    ds_read_b128 v[68:71], v107 offset:0
    ds_read_b128 v[88:91], v108 offset:1120
    s_waitcnt lgkmcnt(0)
    v_mfma_f32_32x32x16_bf16 v[0:15], v[88:91], v[68:71], v[0:15]
    ds_read_b128 v[64:67], v104 offset:16384
    ds_read_b128 v[72:75], v108 offset:1152
    s_barrier
    s_waitcnt lgkmcnt(0)
    v_mfma_f32_32x32x16_bf16 v[0:15], v[72:75], v[64:67], v[0:15]
    ds_read_b128 v[68:71], v105 offset:16384
    ds_read_b128 v[88:91], v108 offset:1184
    s_waitcnt lgkmcnt(0)
    v_mfma_f32_32x32x16_bf16 v[0:15], v[88:91], v[68:71], v[0:15]
    ds_read_b128 v[64:67], v106 offset:16384
    ds_read_b128 v[72:75], v108 offset:1216
    s_waitcnt lgkmcnt(0)
    v_mfma_f32_32x32x16_bf16 v[0:15], v[72:75], v[64:67], v[0:15]
    ds_read_b128 v[68:71], v107 offset:16384
    ds_read_b128 v[88:91], v108 offset:1248
    s_waitcnt lgkmcnt(0)
    v_mfma_f32_32x32x16_bf16 v[0:15], v[88:91], v[68:71], v[0:15]
    s_nop 15
    s_mov_b32 s40, 0xbfb8aa3b
    v_mul_f32 v119, s40, v0
    v_exp_f32 v119, v119
    s_nop 0
    v_add_f32 v119, 1.0, v119
    v_rcp_f32 v119, v119
    s_lshl_b32 s36, s25, 7
    s_lshl_b32 s37, s27, 5
    s_add_u32 s36, s36, s37
    s_lshl_b32 s36, s36, 2
    s_add_u32 s36, s36, 16777216
    v_lshlrev_b32 v120, 2, v117
    s_mov_b32 exec_hi, 0
    buffer_store_dword v119, v120, s[4:7], s36 offen
    s_mov_b64 exec, -1
L_k1_fin:
    s_endpgm
L_k1_prod:
    s_setprio 3
    s_sub_u32 s29, s24, 8
    v_and_b32 v4, 63, v0
    s_mul_i32 s36, s29, 3
    s_lshl_b32 s35, s36, 10
    s_lshl_b32 s37, s25, 7
    s_lshl_b32 s39, s36, 3
    s_add_u32 s37, s37, s39
    s_mul_i32 s30, s37, 1280
    s_and_b32 s36, s29, 1
    s_lshl_b32 s36, s36, 2
    v_lshrrev_b32 v5, 3, v4
    v_mul_u32_u24 v5, 1280, v5
    v_lshrrev_b32 v6, 4, v4
    v_and_b32 v7, 7, v4
    v_add_u32 v0, s36, v6
    v_and_b32 v0, 7, v0
    v_xor_b32 v0, v0, v7
    v_lshl_add_u32 v0, v0, 4, v5
    s_xor_b32 s36, s36, 4
    v_add_u32 v8, s36, v6
    v_and_b32 v8, 7, v8
    v_xor_b32 v8, v8, v7
    v_lshl_add_u32 v8, v8, 4, v5
    s_lshl_b32 s38, s29, 10
    s_lshl_b32 s36, s29, 2
    s_mul_i32 s32, s36, 3840
    s_lshl_b32 s37, s26, 8
    s_add_u32 s32, s32, s37
    v_lshrrev_b32 v5, 4, v4
    v_mul_u32_u24 v1, 3840, v5
    v_lshlrev_b32 v6, 2, v5
    v_and_b32 v7, 15, v4
    v_xor_b32 v6, v6, v7
    v_lshl_add_u32 v1, v6, 4, v1
    s_mul_i32 s34, s26, 192
    s_mov_b32 s39, 0x15555556
    s_lshl_b32 s36, s29, 6
    v_add_u32 v5, s36, v4
    v_mul_hi_u32 v6, v5, s39
    v_mul_u32_u24 v7, 12, v6
    v_sub_u32 v7, v5, v7
    v_mul_u32_u24 v2, 3072, v6
    v_lshl_add_u32 v2, v7, 4, v2
    v_lshlrev_b32 v5, 4, v4
    s_waitcnt lgkmcnt(0)
    s_mov_b32 s6, 22194176
    s_mov_b32 s7, 0x20000
    s_mov_b32 s10, 2621440
    s_mov_b32 s11, 0x20000
    s_mov_b32 s14, 2457600
    s_mov_b32 s15, 0x20000
    s_mov_b32 s18, 1966080
    s_mov_b32 s19, 0x20000
    s_mov_b32 s22, 3072
    s_mov_b32 s23, 0x20000
    s_mov_b32 s46, 1280
    s_mov_b32 s47, 0x20000
    s_cmp_lt_u32 s29, 3
    s_cbranch_scc0 L_k1_prod3
    s_add_u32 m0, s35, 0
    s_nop 0
    buffer_load_dwordx4 v0, s[8:11], s30 offen lds
    s_add_u32 m0, s35, 1024
    s_add_u32 s31, s30, 10240
    buffer_load_dwordx4 v8, s[8:11], s31 offen lds
    s_add_u32 m0, s35, 2048
    s_add_u32 s31, s30, 20480
    buffer_load_dwordx4 v0, s[8:11], s31 offen lds
    s_add_u32 s30, s30, 128
    s_add_u32 m0, s38, 65536
    s_nop 0
    buffer_load_dwordx4 v1, s[12:15], s32 offen lds
    s_add_u32 m0, s38, 118784
    s_nop 0
    buffer_load_dwordx4 v2, s[16:19], s34 offen lds
    s_add_u32 s32, s32, 61440
    s_add_u32 s34, s34, 49152
    s_add_u32 m0, s38, 69632
    s_nop 0
    buffer_load_dwordx4 v1, s[12:15], s32 offen lds
    s_add_u32 m0, s38, 121856
    s_nop 0
    buffer_load_dwordx4 v2, s[16:19], s34 offen lds
    s_add_u32 s32, s32, 61440
    s_add_u32 s34, s34, 49152
    s_add_u32 m0, s38, 73728
    s_nop 0
    buffer_load_dwordx4 v1, s[12:15], s32 offen lds
    s_add_u32 m0, s38, 124928
    s_nop 0
    buffer_load_dwordx4 v2, s[16:19], s34 offen lds
    s_add_u32 s32, s32, 61440
    s_add_u32 s34, s34, 49152
    s_add_u32 m0, s38, 77824
    s_nop 0
    buffer_load_dwordx4 v1, s[12:15], s32 offen lds
    s_add_u32 m0, s38, 128000
    s_nop 0
    buffer_load_dwordx4 v2, s[16:19], s34 offen lds
    s_add_u32 s32, s32, 61440
    s_add_u32 s34, s34, 49152
    s_waitcnt vmcnt(0)
    v_mov_b32 v6, 160064
    v_mov_b32 v7, 1
    s_mov_b64 exec, 1
    ds_add_u32 v6, v7
    s_mov_b64 exec, -1
    s_add_u32 m0, s35, 16384
    s_nop 0
    buffer_load_dwordx4 v0, s[8:11], s30 offen lds
    s_add_u32 m0, s35, 17408
    s_add_u32 s31, s30, 10240
    buffer_load_dwordx4 v8, s[8:11], s31 offen lds
    s_add_u32 m0, s35, 18432
    s_add_u32 s31, s30, 20480
    buffer_load_dwordx4 v0, s[8:11], s31 offen lds
    s_add_u32 s30, s30, 128
    s_add_u32 m0, s38, 81920
    s_nop 0
    buffer_load_dwordx4 v1, s[12:15], s32 offen lds
    s_add_u32 m0, s38, 131072
    s_nop 0
    buffer_load_dwordx4 v2, s[16:19], s34 offen lds
    s_add_u32 s32, s32, 61440
    s_add_u32 s34, s34, 49152
    s_add_u32 m0, s38, 86016
    s_nop 0
    buffer_load_dwordx4 v1, s[12:15], s32 offen lds
    s_add_u32 m0, s38, 134144
    s_nop 0
    buffer_load_dwordx4 v2, s[16:19], s34 offen lds
    s_add_u32 s32, s32, 61440
    s_add_u32 s34, s34, 49152
    s_add_u32 m0, s38, 90112
    s_nop 0
    buffer_load_dwordx4 v1, s[12:15], s32 offen lds
    s_add_u32 m0, s38, 137216
    s_nop 0
    buffer_load_dwordx4 v2, s[16:19], s34 offen lds
    s_add_u32 s32, s32, 61440
    s_add_u32 s34, s34, 49152
    s_add_u32 m0, s38, 94208
    s_nop 0
    buffer_load_dwordx4 v1, s[12:15], s32 offen lds
    s_add_u32 m0, s38, 140288
    s_nop 0
    buffer_load_dwordx4 v2, s[16:19], s34 offen lds
    s_add_u32 s32, s32, 61440
    s_add_u32 s34, s34, 49152
    s_add_u32 m0, s38, 98304
    s_nop 0
    buffer_load_dwordx4 v1, s[12:15], s32 offen lds
    s_add_u32 m0, s38, 143360
    s_nop 0
    buffer_load_dwordx4 v2, s[16:19], s34 offen lds
    s_add_u32 s32, s32, 61440
    s_add_u32 s34, s34, 49152
    s_add_u32 m0, s35, 32768
    s_nop 0
    buffer_load_dwordx4 v0, s[8:11], s30 offen lds
    s_add_u32 m0, s35, 33792
    s_add_u32 s31, s30, 10240
    buffer_load_dwordx4 v8, s[8:11], s31 offen lds
    s_add_u32 m0, s35, 34816
    s_add_u32 s31, s30, 20480
    buffer_load_dwordx4 v0, s[8:11], s31 offen lds
    s_add_u32 s30, s30, 128
    s_add_u32 m0, s38, 102400
    s_nop 0
    buffer_load_dwordx4 v1, s[12:15], s32 offen lds
    s_add_u32 m0, s38, 146432
    s_nop 0
    buffer_load_dwordx4 v2, s[16:19], s34 offen lds
    s_add_u32 s32, s32, 61440
    s_add_u32 s34, s34, 49152
    s_add_u32 m0, s38, 106496
    s_nop 0
    buffer_load_dwordx4 v1, s[12:15], s32 offen lds
    s_add_u32 m0, s38, 149504
    s_nop 0
    buffer_load_dwordx4 v2, s[16:19], s34 offen lds
    s_add_u32 s32, s32, 61440
    s_add_u32 s34, s34, 49152
    s_add_u32 m0, s38, 110592
    s_nop 0
    buffer_load_dwordx4 v1, s[12:15], s32 offen lds
    s_add_u32 m0, s38, 152576
    s_nop 0
    buffer_load_dwordx4 v2, s[16:19], s34 offen lds
    s_add_u32 s32, s32, 61440
    s_add_u32 s34, s34, 49152
    s_add_u32 m0, s38, 114688
    s_nop 0
    buffer_load_dwordx4 v1, s[12:15], s32 offen lds
    s_add_u32 m0, s38, 155648
    s_nop 0
    buffer_load_dwordx4 v2, s[16:19], s34 offen lds
    s_add_u32 s32, s32, 61440
    s_add_u32 s34, s34, 49152
    s_add_u32 m0, s35, 49152
    s_nop 0
    buffer_load_dwordx4 v0, s[8:11], s30 offen lds
    s_add_u32 m0, s35, 50176
    s_add_u32 s31, s30, 10240
    buffer_load_dwordx4 v8, s[8:11], s31 offen lds
    s_add_u32 m0, s35, 51200
    s_add_u32 s31, s30, 20480
    buffer_load_dwordx4 v0, s[8:11], s31 offen lds
    s_add_u32 s30, s30, 128
    s_waitcnt vmcnt(11)
    s_barrier
    s_add_u32 m0, s38, 65536
    s_nop 0
    buffer_load_dwordx4 v1, s[12:15], s32 offen lds
    s_add_u32 m0, s38, 118784
    s_nop 0
    buffer_load_dwordx4 v2, s[16:19], s34 offen lds
    s_add_u32 s32, s32, 61440
    s_add_u32 s34, s34, 49152
    s_add_u32 m0, s38, 69632
    s_nop 0
    buffer_load_dwordx4 v1, s[12:15], s32 offen lds
    s_add_u32 m0, s38, 121856
    s_nop 0
    buffer_load_dwordx4 v2, s[16:19], s34 offen lds
    s_add_u32 s32, s32, 61440
    s_add_u32 s34, s34, 49152
    s_add_u32 m0, s38, 73728
    s_nop 0
    buffer_load_dwordx4 v1, s[12:15], s32 offen lds
    s_add_u32 m0, s38, 124928
    s_nop 0
    buffer_load_dwordx4 v2, s[16:19], s34 offen lds
    s_add_u32 s32, s32, 61440
    s_add_u32 s34, s34, 49152
    s_add_u32 m0, s38, 77824
    s_nop 0
    buffer_load_dwordx4 v1, s[12:15], s32 offen lds
    s_add_u32 m0, s38, 128000
    s_nop 0
    buffer_load_dwordx4 v2, s[16:19], s34 offen lds
    s_add_u32 s32, s32, 61440
    s_add_u32 s34, s34, 49152
    s_add_u32 m0, s35, 0
    s_nop 0
    buffer_load_dwordx4 v0, s[8:11], s30 offen lds
    s_add_u32 m0, s35, 1024
    s_add_u32 s31, s30, 10240
    buffer_load_dwordx4 v8, s[8:11], s31 offen lds
    s_add_u32 m0, s35, 2048
    s_add_u32 s31, s30, 20480
    buffer_load_dwordx4 v0, s[8:11], s31 offen lds
    s_add_u32 s30, s30, 128
    s_waitcnt vmcnt(11)
    s_barrier
    s_add_u32 m0, s38, 81920
    s_nop 0
    buffer_load_dwordx4 v1, s[12:15], s32 offen lds
    s_add_u32 m0, s38, 131072
    s_nop 0
    buffer_load_dwordx4 v2, s[16:19], s34 offen lds
    s_add_u32 s32, s32, 61440
    s_add_u32 s34, s34, 49152
    s_add_u32 m0, s38, 86016
    s_nop 0
    buffer_load_dwordx4 v1, s[12:15], s32 offen lds
    s_add_u32 m0, s38, 134144
    s_nop 0
    buffer_load_dwordx4 v2, s[16:19], s34 offen lds
    s_add_u32 s32, s32, 61440
    s_add_u32 s34, s34, 49152
    s_add_u32 m0, s38, 90112
    s_nop 0
    buffer_load_dwordx4 v1, s[12:15], s32 offen lds
    s_add_u32 m0, s38, 137216
    s_nop 0
    buffer_load_dwordx4 v2, s[16:19], s34 offen lds
    s_add_u32 s32, s32, 61440
    s_add_u32 s34, s34, 49152
    s_add_u32 m0, s38, 94208
    s_nop 0
    buffer_load_dwordx4 v1, s[12:15], s32 offen lds
    s_add_u32 m0, s38, 140288
    s_nop 0
    buffer_load_dwordx4 v2, s[16:19], s34 offen lds
    s_add_u32 s32, s32, 61440
    s_add_u32 s34, s34, 49152
    s_add_u32 m0, s35, 16384
    s_nop 0
    buffer_load_dwordx4 v0, s[8:11], s30 offen lds
    s_add_u32 m0, s35, 17408
    s_add_u32 s31, s30, 10240
    buffer_load_dwordx4 v8, s[8:11], s31 offen lds
    s_add_u32 m0, s35, 18432
    s_add_u32 s31, s30, 20480
    buffer_load_dwordx4 v0, s[8:11], s31 offen lds
    s_add_u32 s30, s30, 128
    s_waitcnt vmcnt(11)
    s_barrier
    s_add_u32 m0, s38, 98304
    s_nop 0
    buffer_load_dwordx4 v1, s[12:15], s32 offen lds
    s_add_u32 m0, s38, 143360
    s_nop 0
    buffer_load_dwordx4 v2, s[16:19], s34 offen lds
    s_add_u32 s32, s32, 61440
    s_add_u32 s34, s34, 49152
    s_add_u32 m0, s38, 102400
    s_nop 0
    buffer_load_dwordx4 v1, s[12:15], s32 offen lds
    s_add_u32 m0, s38, 146432
    s_nop 0
    buffer_load_dwordx4 v2, s[16:19], s34 offen lds
    s_add_u32 s32, s32, 61440
    s_add_u32 s34, s34, 49152
    s_add_u32 m0, s38, 106496
    s_nop 0
    buffer_load_dwordx4 v1, s[12:15], s32 offen lds
    s_add_u32 m0, s38, 149504
    s_nop 0
    buffer_load_dwordx4 v2, s[16:19], s34 offen lds
    s_add_u32 s32, s32, 61440
    s_add_u32 s34, s34, 49152
    s_add_u32 m0, s38, 110592
    s_nop 0
    buffer_load_dwordx4 v1, s[12:15], s32 offen lds
    s_add_u32 m0, s38, 152576
    s_nop 0
    buffer_load_dwordx4 v2, s[16:19], s34 offen lds
    s_add_u32 s32, s32, 61440
    s_add_u32 s34, s34, 49152
    s_add_u32 m0, s35, 32768
    s_nop 0
    buffer_load_dwordx4 v0, s[8:11], s30 offen lds
    s_add_u32 m0, s35, 33792
    s_add_u32 s31, s30, 10240
    buffer_load_dwordx4 v8, s[8:11], s31 offen lds
    s_add_u32 m0, s35, 34816
    s_add_u32 s31, s30, 20480
    buffer_load_dwordx4 v0, s[8:11], s31 offen lds
    s_add_u32 s30, s30, 128
    s_waitcnt vmcnt(11)
    s_barrier
    s_add_u32 m0, s38, 114688
    s_nop 0
    buffer_load_dwordx4 v1, s[12:15], s32 offen lds
    s_add_u32 m0, s38, 155648
    s_nop 0
    buffer_load_dwordx4 v2, s[16:19], s34 offen lds
    s_add_u32 s32, s32, 61440
    s_add_u32 s34, s34, 49152
    s_add_u32 m0, s38, 65536
    s_nop 0
    buffer_load_dwordx4 v1, s[12:15], s32 offen lds
    s_add_u32 m0, s38, 118784
    s_nop 0
    buffer_load_dwordx4 v2, s[16:19], s34 offen lds
    s_add_u32 s32, s32, 61440
    s_add_u32 s34, s34, 49152
    s_add_u32 m0, s38, 69632
    s_nop 0
    buffer_load_dwordx4 v1, s[12:15], s32 offen lds
    s_add_u32 m0, s38, 121856
    s_nop 0
    buffer_load_dwordx4 v2, s[16:19], s34 offen lds
    s_add_u32 s32, s32, 61440
    s_add_u32 s34, s34, 49152
    s_add_u32 m0, s38, 73728
    s_nop 0
    buffer_load_dwordx4 v1, s[12:15], s32 offen lds
    s_add_u32 m0, s38, 124928
    s_nop 0
    buffer_load_dwordx4 v2, s[16:19], s34 offen lds
    s_add_u32 s32, s32, 61440
    s_add_u32 s34, s34, 49152
    s_add_u32 m0, s35, 49152
    s_nop 0
    buffer_load_dwordx4 v0, s[8:11], s30 offen lds
    s_add_u32 m0, s35, 50176
    s_add_u32 s31, s30, 10240
    buffer_load_dwordx4 v8, s[8:11], s31 offen lds
    s_add_u32 m0, s35, 51200
    s_add_u32 s31, s30, 20480
    buffer_load_dwordx4 v0, s[8:11], s31 offen lds
    s_add_u32 s30, s30, 128
    s_waitcnt vmcnt(11)
    s_barrier
    s_add_u32 m0, s38, 77824
    s_nop 0
    buffer_load_dwordx4 v1, s[12:15], s32 offen lds
    s_add_u32 m0, s38, 128000
    s_nop 0
    buffer_load_dwordx4 v2, s[16:19], s34 offen lds
    s_add_u32 s32, s32, 61440
    s_add_u32 s34, s34, 49152
    s_add_u32 m0, s38, 81920
    s_nop 0
    buffer_load_dwordx4 v1, s[12:15], s32 offen lds
    s_add_u32 m0, s38, 131072
    s_nop 0
    buffer_load_dwordx4 v2, s[16:19], s34 offen lds
    s_add_u32 s32, s32, 61440
    s_add_u32 s34, s34, 49152
    s_add_u32 m0, s38, 86016
    s_nop 0
    buffer_load_dwordx4 v1, s[12:15], s32 offen lds
    s_add_u32 m0, s38, 134144
    s_nop 0
    buffer_load_dwordx4 v2, s[16:19], s34 offen lds
    s_add_u32 s32, s32, 61440
    s_add_u32 s34, s34, 49152
    s_add_u32 m0, s38, 90112
    s_nop 0
    buffer_load_dwordx4 v1, s[12:15], s32 offen lds
    s_add_u32 m0, s38, 137216
    s_nop 0
    buffer_load_dwordx4 v2, s[16:19], s34 offen lds
    s_add_u32 s32, s32, 61440
    s_add_u32 s34, s34, 49152
    s_add_u32 m0, s35, 0
    s_nop 0
    buffer_load_dwordx4 v0, s[8:11], s30 offen lds
    s_add_u32 m0, s35, 1024
    s_add_u32 s31, s30, 10240
    buffer_load_dwordx4 v8, s[8:11], s31 offen lds
    s_add_u32 m0, s35, 2048
    s_add_u32 s31, s30, 20480
    buffer_load_dwordx4 v0, s[8:11], s31 offen lds
    s_add_u32 s30, s30, 128
    s_waitcnt vmcnt(11)
    s_barrier
    s_add_u32 m0, s38, 94208
    s_nop 0
    buffer_load_dwordx4 v1, s[12:15], s32 offen lds
    s_add_u32 m0, s38, 140288
    s_nop 0
    buffer_load_dwordx4 v2, s[16:19], s34 offen lds
    s_add_u32 s32, s32, 61440
    s_add_u32 s34, s34, 49152
    s_add_u32 m0, s38, 98304
    s_nop 0
    buffer_load_dwordx4 v1, s[12:15], s32 offen lds
    s_add_u32 m0, s38, 143360
    s_nop 0
    buffer_load_dwordx4 v2, s[16:19], s34 offen lds
    s_add_u32 s32, s32, 61440
    s_add_u32 s34, s34, 49152
    s_add_u32 m0, s38, 102400
    s_nop 0
    buffer_load_dwordx4 v1, s[12:15], s32 offen lds
    s_add_u32 m0, s38, 146432
    s_nop 0
    buffer_load_dwordx4 v2, s[16:19], s34 offen lds
    s_add_u32 s32, s32, 61440
    s_add_u32 s34, s34, 49152
    s_add_u32 m0, s38, 106496
    s_nop 0
    buffer_load_dwordx4 v1, s[12:15], s32 offen lds
    s_add_u32 m0, s38, 149504
    s_nop 0
    buffer_load_dwordx4 v2, s[16:19], s34 offen lds
    s_add_u32 s32, s32, 61440
    s_add_u32 s34, s34, 49152
    s_add_u32 m0, s35, 16384
    s_nop 0
    buffer_load_dwordx4 v0, s[8:11], s30 offen lds
    s_add_u32 m0, s35, 17408
    s_add_u32 s31, s30, 10240
    buffer_load_dwordx4 v8, s[8:11], s31 offen lds
    s_add_u32 m0, s35, 18432
    s_add_u32 s31, s30, 20480
    buffer_load_dwordx4 v0, s[8:11], s31 offen lds
    s_add_u32 s30, s30, 128
    s_waitcnt vmcnt(11)
    s_barrier
    s_add_u32 m0, s38, 110592
    s_nop 0
    buffer_load_dwordx4 v1, s[12:15], s32 offen lds
    s_add_u32 m0, s38, 152576
    s_nop 0
    buffer_load_dwordx4 v2, s[16:19], s34 offen lds
    s_add_u32 s32, s32, 61440
    s_add_u32 s34, s34, 49152
    s_add_u32 m0, s38, 114688
    s_nop 0
    buffer_load_dwordx4 v1, s[12:15], s32 offen lds
    s_add_u32 m0, s38, 155648
    s_nop 0
    buffer_load_dwordx4 v2, s[16:19], s34 offen lds
    s_add_u32 s32, s32, 61440
    s_add_u32 s34, s34, 49152
    s_add_u32 m0, s38, 65536
    s_nop 0
    buffer_load_dwordx4 v1, s[12:15], s32 offen lds
    s_add_u32 m0, s38, 118784
    s_nop 0
    buffer_load_dwordx4 v2, s[16:19], s34 offen lds
    s_add_u32 s32, s32, 61440
    s_add_u32 s34, s34, 49152
    s_waitcnt vmcnt(6)
    s_barrier
    s_waitcnt vmcnt(0)
    s_barrier
    s_cmp_eq_u32 s29, 0
    s_cbranch_scc0 L_lw_end
    s_getpc_b64 s[48:49]
L_lw_pc:
    s_add_u32 s48, s48, (attn_kernel - L_lw_pc)
    s_addc_u32 s49, s49, 0
    s_lshr_b32 s36, s2, 3
    s_mul_i32 s36, s36, ((L_code_end - attn_kernel)/4096 + 1)
    v_min_u32 v5, ((L_code_end - attn_kernel)/4096), v4
    v_add_u32 v5, s36, v5
    v_lshlrev_b32 v5, 7, v5
    v_min_u32 v5, (L_code_end - attn_kernel - 4), v5
    global_load_dword v9, v5, s[48:49]
L_lw_end:
    s_load_dwordx2 s[48:49], s[0:1], 48
    s_load_dwordx2 s[50:51], s[0:1], 16
    s_lshl_b32 s36, s2, 2
    s_add_u32 s36, s36, s29
    s_mul_i32 s36, s36, 3
    s_mul_i32 s37, s29, 3072
    v_lshrrev_b32 v5, 2, v4
    v_mul_u32_u24 v0, 1280, v5
    v_and_b32 v6, 3, v4
    v_lshl_add_u32 v0, v6, 4, v0
    v_lshrrev_b32 v5, 4, v4
    v_mul_u32_u24 v5, 20, v5
    v_bfe_u32 v6, v4, 2, 2
    v_add_u32 v5, v5, v6
    v_mul_u32_u24 v3, 1280, v5
    v_and_b32 v6, 3, v4
    v_lshl_add_u32 v3, v6, 4, v3
    v_lshrrev_b32 v5, 5, v4
    v_bfe_u32 v6, v4, 2, 2
    v_lshl_add_u32 v5, v5, 3, v6
    v_lshlrev_b32 v5, 6, v5
    v_bfe_u32 v6, v4, 4, 1
    v_lshl_add_u32 v5, v6, 5, v5
    v_and_b32 v6, 3, v4
    v_lshl_add_u32 v1, v6, 3, v5
    v_add_u32 v1, s37, v1
    v_lshlrev_b32 v2, 4, v4
    s_waitcnt lgkmcnt(0)
    s_add_u32 s38, s36, 0
    s_min_u32 s38, s38, 2719
    s_mul_hi_u32 s39, s38, 0x0ccccccd
    s_mul_i32 s40, s39, 20
    s_sub_u32 s40, s38, s40
    s_cmp_ge_u32 s39, 96
    s_cselect_b32 s52, s50, s48
    s_cselect_b32 s53, s51, s49
    s_mov_b32 s54, 1966080
    s_cselect_b32 s54, 819200, s54
    s_mov_b32 s55, 0x20000
    s_cselect_b32 s41, 96, 0
    s_mov_b32 s42, 96
    s_cselect_b32 s42, 40, s42
    s_mov_b32 s43, 19406848
    s_cselect_b32 s43, 21372928, s43
    s_sub_u32 s41, s39, s41
    s_mul_i32 s42, s42, s40
    s_add_u32 s42, s42, s41
    s_lshl_b32 s42, s42, 10
    s_add_u32 s56, s42, s43
    s_cmp_ge_u32 s39, 96
    s_cselect_b32 s46, 20, 16
    s_mul_i32 s47, s41, s46
    s_cmp_ge_u32 s39, 128
    s_cselect_b32 s46, 1, 0
    s_sub_u32 s45, s39, 128
    s_mul_i32 s45, s45, 80
    s_add_u32 s45, s45, 16
    s_cmp_eq_u32 s46, 1
    s_cselect_b32 s47, s45, s47
    s_mul_i32 s41, s47, 1280
    s_lshl_b32 s40, s40, 6
    s_add_u32 s41, s41, s40
    s_add_u32 m0, s37, 0
    s_cmp_eq_u32 s46, 1
    s_cbranch_scc1 L_wt_tail_a0
    buffer_load_dwordx4 v0, s[52:55], s41 offen lds
    s_branch L_wt_next_a0
L_wt_tail_a0:
    buffer_load_dwordx4 v3, s[52:55], s41 offen lds
L_wt_next_a0:
    s_add_u32 s38, s36, 1
    s_min_u32 s38, s38, 2719
    s_mul_hi_u32 s39, s38, 0x0ccccccd
    s_mul_i32 s40, s39, 20
    s_sub_u32 s40, s38, s40
    s_cmp_ge_u32 s39, 96
    s_cselect_b32 s52, s50, s48
    s_cselect_b32 s53, s51, s49
    s_mov_b32 s54, 1966080
    s_cselect_b32 s54, 819200, s54
    s_mov_b32 s55, 0x20000
    s_cselect_b32 s41, 96, 0
    s_mov_b32 s42, 96
    s_cselect_b32 s42, 40, s42
    s_mov_b32 s43, 19406848
    s_cselect_b32 s43, 21372928, s43
    s_sub_u32 s41, s39, s41
    s_mul_i32 s42, s42, s40
    s_add_u32 s42, s42, s41
    s_lshl_b32 s42, s42, 10
    s_add_u32 s57, s42, s43
    s_cmp_ge_u32 s39, 96
    s_cselect_b32 s46, 20, 16
    s_mul_i32 s47, s41, s46
    s_cmp_ge_u32 s39, 128
    s_cselect_b32 s46, 1, 0
    s_sub_u32 s45, s39, 128
    s_mul_i32 s45, s45, 80
    s_add_u32 s45, s45, 16
    s_cmp_eq_u32 s46, 1
    s_cselect_b32 s47, s45, s47
    s_mul_i32 s41, s47, 1280
    s_lshl_b32 s40, s40, 6
    s_add_u32 s41, s41, s40
    s_add_u32 m0, s37, 1024
    s_cmp_eq_u32 s46, 1
    s_cbranch_scc1 L_wt_tail_a1
    buffer_load_dwordx4 v0, s[52:55], s41 offen lds
    s_branch L_wt_next_a1
L_wt_tail_a1:
    buffer_load_dwordx4 v3, s[52:55], s41 offen lds
L_wt_next_a1:
    s_add_u32 s38, s36, 2
    s_min_u32 s38, s38, 2719
    s_mul_hi_u32 s39, s38, 0x0ccccccd
    s_mul_i32 s40, s39, 20
    s_sub_u32 s40, s38, s40
    s_cmp_ge_u32 s39, 96
    s_cselect_b32 s52, s50, s48
    s_cselect_b32 s53, s51, s49
    s_mov_b32 s54, 1966080
    s_cselect_b32 s54, 819200, s54
    s_mov_b32 s55, 0x20000
    s_cselect_b32 s41, 96, 0
    s_mov_b32 s42, 96
    s_cselect_b32 s42, 40, s42
    s_mov_b32 s43, 19406848
    s_cselect_b32 s43, 21372928, s43
    s_sub_u32 s41, s39, s41
    s_mul_i32 s42, s42, s40
    s_add_u32 s42, s42, s41
    s_lshl_b32 s42, s42, 10
    s_add_u32 s58, s42, s43
    s_cmp_ge_u32 s39, 96
    s_cselect_b32 s46, 20, 16
    s_mul_i32 s47, s41, s46
    s_cmp_ge_u32 s39, 128
    s_cselect_b32 s46, 1, 0
    s_sub_u32 s45, s39, 128
    s_mul_i32 s45, s45, 80
    s_add_u32 s45, s45, 16
    s_cmp_eq_u32 s46, 1
    s_cselect_b32 s47, s45, s47
    s_mul_i32 s41, s47, 1280
    s_lshl_b32 s40, s40, 6
    s_add_u32 s41, s41, s40
    s_add_u32 m0, s37, 2048
    s_cmp_eq_u32 s46, 1
    s_cbranch_scc1 L_wt_tail_a2
    buffer_load_dwordx4 v0, s[52:55], s41 offen lds
    s_branch L_wt_next_a2
L_wt_tail_a2:
    buffer_load_dwordx4 v3, s[52:55], s41 offen lds
L_wt_next_a2:
    s_waitcnt vmcnt(2)
    ds_read_b64_tr_b16 v[16:17], v1 offset:0
    ds_read_b64_tr_b16 v[18:19], v1 offset:256
    s_waitcnt vmcnt(1)
    ds_read_b64_tr_b16 v[20:21], v1 offset:1024
    ds_read_b64_tr_b16 v[22:23], v1 offset:1280
    s_waitcnt vmcnt(0)
    ds_read_b64_tr_b16 v[24:25], v1 offset:2048
    ds_read_b64_tr_b16 v[26:27], v1 offset:2304
    s_waitcnt lgkmcnt(4)
    buffer_store_dwordx4 v[16:19], v2, s[4:7], s56 offen nt
    s_waitcnt lgkmcnt(2)
    buffer_store_dwordx4 v[20:23], v2, s[4:7], s57 offen nt
    s_waitcnt lgkmcnt(0)
    buffer_store_dwordx4 v[24:27], v2, s[4:7], s58 offen nt
    s_endpgm
L_k1_prod3:
    s_mov_b32 s36, 0
    s_mov_b32 m0, 158720
    s_nop 0
    buffer_load_dwordx4 v5, s[44:47], s36 offen lds
    s_mov_b64 exec, 0xffff
    buffer_load_dwordx4 v5, s[44:47], s36 offen offset:1024 lds
    s_mov_b64 exec, -1
    s_add_u32 m0, s35, 0
    s_nop 0
    buffer_load_dwordx4 v0, s[8:11], s30 offen lds
    s_add_u32 m0, s35, 1024
    s_add_u32 s31, s30, 10240
    buffer_load_dwordx4 v8, s[8:11], s31 offen lds
    s_add_u32 m0, s35, 2048
    s_add_u32 s31, s30, 20480
    buffer_load_dwordx4 v0, s[8:11], s31 offen lds
    s_add_u32 m0, s35, 3072
    s_add_u32 s31, s30, 30720
    buffer_load_dwordx4 v8, s[8:11], s31 offen lds
    s_add_u32 m0, s35, 4096
    s_add_u32 s31, s30, 40960
    buffer_load_dwordx4 v0, s[8:11], s31 offen lds
    s_add_u32 m0, s35, 5120
    s_add_u32 s31, s30, 51200
    buffer_load_dwordx4 v8, s[8:11], s31 offen lds
    s_add_u32 m0, s35, 6144
    s_add_u32 s31, s30, 61440
    buffer_load_dwordx4 v0, s[8:11], s31 offen lds
    s_add_u32 s30, s30, 128
    s_add_u32 m0, s38, 65536
    s_nop 0
    buffer_load_dwordx4 v1, s[12:15], s32 offen lds
    s_add_u32 s32, s32, 61440
    s_add_u32 s34, s34, 49152
    s_add_u32 m0, s38, 69632
    s_nop 0
    buffer_load_dwordx4 v1, s[12:15], s32 offen lds
    s_add_u32 s32, s32, 61440
    s_add_u32 s34, s34, 49152
    s_add_u32 m0, s38, 73728
    s_nop 0
    buffer_load_dwordx4 v1, s[12:15], s32 offen lds
    s_add_u32 s32, s32, 61440
    s_add_u32 s34, s34, 49152
    s_add_u32 m0, s38, 77824
    s_nop 0
    buffer_load_dwordx4 v1, s[12:15], s32 offen lds
    s_add_u32 s32, s32, 61440
    s_add_u32 s34, s34, 49152
    s_waitcnt vmcnt(0)
    v_mov_b32 v6, 160064
    v_mov_b32 v7, 1
    s_mov_b64 exec, 1
    ds_add_u32 v6, v7
    s_mov_b64 exec, -1
    s_add_u32 m0, s35, 16384
    s_nop 0
    buffer_load_dwordx4 v0, s[8:11], s30 offen lds
    s_add_u32 m0, s35, 17408
    s_add_u32 s31, s30, 10240
    buffer_load_dwordx4 v8, s[8:11], s31 offen lds
    s_add_u32 m0, s35, 18432
    s_add_u32 s31, s30, 20480
    buffer_load_dwordx4 v0, s[8:11], s31 offen lds
    s_add_u32 m0, s35, 19456
    s_add_u32 s31, s30, 30720
    buffer_load_dwordx4 v8, s[8:11], s31 offen lds
    s_add_u32 m0, s35, 20480
    s_add_u32 s31, s30, 40960
    buffer_load_dwordx4 v0, s[8:11], s31 offen lds
    s_add_u32 m0, s35, 21504
    s_add_u32 s31, s30, 51200
    buffer_load_dwordx4 v8, s[8:11], s31 offen lds
    s_add_u32 m0, s35, 22528
    s_add_u32 s31, s30, 61440
    buffer_load_dwordx4 v0, s[8:11], s31 offen lds
    s_add_u32 s30, s30, 128
    s_add_u32 m0, s38, 81920
    s_nop 0
    buffer_load_dwordx4 v1, s[12:15], s32 offen lds
    s_add_u32 s32, s32, 61440
    s_add_u32 s34, s34, 49152
    s_add_u32 m0, s38, 86016
    s_nop 0
    buffer_load_dwordx4 v1, s[12:15], s32 offen lds
    s_add_u32 s32, s32, 61440
    s_add_u32 s34, s34, 49152
    s_add_u32 m0, s38, 90112
    s_nop 0
    buffer_load_dwordx4 v1, s[12:15], s32 offen lds
    s_add_u32 s32, s32, 61440
    s_add_u32 s34, s34, 49152
    s_add_u32 m0, s38, 94208
    s_nop 0
    buffer_load_dwordx4 v1, s[12:15], s32 offen lds
    s_add_u32 s32, s32, 61440
    s_add_u32 s34, s34, 49152
    s_add_u32 m0, s38, 98304
    s_nop 0
    buffer_load_dwordx4 v1, s[12:15], s32 offen lds
    s_add_u32 s32, s32, 61440
    s_add_u32 s34, s34, 49152
    s_add_u32 m0, s35, 32768
    s_nop 0
    buffer_load_dwordx4 v0, s[8:11], s30 offen lds
    s_add_u32 m0, s35, 33792
    s_add_u32 s31, s30, 10240
    buffer_load_dwordx4 v8, s[8:11], s31 offen lds
    s_add_u32 m0, s35, 34816
    s_add_u32 s31, s30, 20480
    buffer_load_dwordx4 v0, s[8:11], s31 offen lds
    s_add_u32 m0, s35, 35840
    s_add_u32 s31, s30, 30720
    buffer_load_dwordx4 v8, s[8:11], s31 offen lds
    s_add_u32 m0, s35, 36864
    s_add_u32 s31, s30, 40960
    buffer_load_dwordx4 v0, s[8:11], s31 offen lds
    s_add_u32 m0, s35, 37888
    s_add_u32 s31, s30, 51200
    buffer_load_dwordx4 v8, s[8:11], s31 offen lds
    s_add_u32 m0, s35, 38912
    s_add_u32 s31, s30, 61440
    buffer_load_dwordx4 v0, s[8:11], s31 offen lds
    s_add_u32 s30, s30, 128
    s_add_u32 m0, s38, 102400
    s_nop 0
    buffer_load_dwordx4 v1, s[12:15], s32 offen lds
    s_add_u32 s32, s32, 61440
    s_add_u32 s34, s34, 49152
    s_add_u32 m0, s38, 106496
    s_nop 0
    buffer_load_dwordx4 v1, s[12:15], s32 offen lds
    s_add_u32 s32, s32, 61440
    s_add_u32 s34, s34, 49152
    s_add_u32 m0, s38, 110592
    s_nop 0
    buffer_load_dwordx4 v1, s[12:15], s32 offen lds
    s_add_u32 s32, s32, 61440
    s_add_u32 s34, s34, 49152
    s_add_u32 m0, s38, 114688
    s_nop 0
    buffer_load_dwordx4 v1, s[12:15], s32 offen lds
    s_add_u32 s32, s32, 61440
    s_add_u32 s34, s34, 49152
    s_add_u32 m0, s35, 49152
    s_nop 0
    buffer_load_dwordx4 v0, s[8:11], s30 offen lds
    s_add_u32 m0, s35, 50176
    s_add_u32 s31, s30, 10240
    buffer_load_dwordx4 v8, s[8:11], s31 offen lds
    s_add_u32 m0, s35, 51200
    s_add_u32 s31, s30, 20480
    buffer_load_dwordx4 v0, s[8:11], s31 offen lds
    s_add_u32 m0, s35, 52224
    s_add_u32 s31, s30, 30720
    buffer_load_dwordx4 v8, s[8:11], s31 offen lds
    s_add_u32 m0, s35, 53248
    s_add_u32 s31, s30, 40960
    buffer_load_dwordx4 v0, s[8:11], s31 offen lds
    s_add_u32 m0, s35, 54272
    s_add_u32 s31, s30, 51200
    buffer_load_dwordx4 v8, s[8:11], s31 offen lds
    s_add_u32 m0, s35, 55296
    s_add_u32 s31, s30, 61440
    buffer_load_dwordx4 v0, s[8:11], s31 offen lds
    s_add_u32 s30, s30, 128
    s_waitcnt vmcnt(11)
    s_barrier
    s_add_u32 m0, s38, 65536
    s_nop 0
    buffer_load_dwordx4 v1, s[12:15], s32 offen lds
    s_add_u32 s32, s32, 61440
    s_add_u32 s34, s34, 49152
    s_add_u32 m0, s38, 69632
    s_nop 0
    buffer_load_dwordx4 v1, s[12:15], s32 offen lds
    s_add_u32 s32, s32, 61440
    s_add_u32 s34, s34, 49152
    s_add_u32 m0, s38, 73728
    s_nop 0
    buffer_load_dwordx4 v1, s[12:15], s32 offen lds
    s_add_u32 s32, s32, 61440
    s_add_u32 s34, s34, 49152
    s_add_u32 m0, s38, 77824
    s_nop 0
    buffer_load_dwordx4 v1, s[12:15], s32 offen lds
    s_add_u32 s32, s32, 61440
    s_add_u32 s34, s34, 49152
    s_add_u32 m0, s35, 0
    s_nop 0
    buffer_load_dwordx4 v0, s[8:11], s30 offen lds
    s_add_u32 m0, s35, 1024
    s_add_u32 s31, s30, 10240
    buffer_load_dwordx4 v8, s[8:11], s31 offen lds
    s_add_u32 m0, s35, 2048
    s_add_u32 s31, s30, 20480
    buffer_load_dwordx4 v0, s[8:11], s31 offen lds
    s_add_u32 m0, s35, 3072
    s_add_u32 s31, s30, 30720
    buffer_load_dwordx4 v8, s[8:11], s31 offen lds
    s_add_u32 m0, s35, 4096
    s_add_u32 s31, s30, 40960
    buffer_load_dwordx4 v0, s[8:11], s31 offen lds
    s_add_u32 m0, s35, 5120
    s_add_u32 s31, s30, 51200
    buffer_load_dwordx4 v8, s[8:11], s31 offen lds
    s_add_u32 m0, s35, 6144
    s_add_u32 s31, s30, 61440
    buffer_load_dwordx4 v0, s[8:11], s31 offen lds
    s_add_u32 s30, s30, 128
    s_waitcnt vmcnt(11)
    s_barrier
    s_add_u32 m0, s38, 81920
    s_nop 0
    buffer_load_dwordx4 v1, s[12:15], s32 offen lds
    s_add_u32 s32, s32, 61440
    s_add_u32 s34, s34, 49152
    s_add_u32 m0, s38, 86016
    s_nop 0
    buffer_load_dwordx4 v1, s[12:15], s32 offen lds
    s_add_u32 s32, s32, 61440
    s_add_u32 s34, s34, 49152
    s_add_u32 m0, s38, 90112
    s_nop 0
    buffer_load_dwordx4 v1, s[12:15], s32 offen lds
    s_add_u32 s32, s32, 61440
    s_add_u32 s34, s34, 49152
    s_add_u32 m0, s38, 94208
    s_nop 0
    buffer_load_dwordx4 v1, s[12:15], s32 offen lds
    s_add_u32 s32, s32, 61440
    s_add_u32 s34, s34, 49152
    s_add_u32 m0, s35, 16384
    s_nop 0
    buffer_load_dwordx4 v0, s[8:11], s30 offen lds
    s_add_u32 m0, s35, 17408
    s_add_u32 s31, s30, 10240
    buffer_load_dwordx4 v8, s[8:11], s31 offen lds
    s_add_u32 m0, s35, 18432
    s_add_u32 s31, s30, 20480
    buffer_load_dwordx4 v0, s[8:11], s31 offen lds
    s_add_u32 m0, s35, 19456
    s_add_u32 s31, s30, 30720
    buffer_load_dwordx4 v8, s[8:11], s31 offen lds
    s_add_u32 m0, s35, 20480
    s_add_u32 s31, s30, 40960
    buffer_load_dwordx4 v0, s[8:11], s31 offen lds
    s_add_u32 m0, s35, 21504
    s_add_u32 s31, s30, 51200
    buffer_load_dwordx4 v8, s[8:11], s31 offen lds
    s_add_u32 m0, s35, 22528
    s_add_u32 s31, s30, 61440
    buffer_load_dwordx4 v0, s[8:11], s31 offen lds
    s_add_u32 s30, s30, 128
    s_waitcnt vmcnt(11)
    s_barrier
    s_add_u32 m0, s38, 98304
    s_nop 0
    buffer_load_dwordx4 v1, s[12:15], s32 offen lds
    s_add_u32 s32, s32, 61440
    s_add_u32 s34, s34, 49152
    s_add_u32 m0, s38, 102400
    s_nop 0
    buffer_load_dwordx4 v1, s[12:15], s32 offen lds
    s_add_u32 s32, s32, 61440
    s_add_u32 s34, s34, 49152
    s_add_u32 m0, s38, 106496
    s_nop 0
    buffer_load_dwordx4 v1, s[12:15], s32 offen lds
    s_add_u32 s32, s32, 61440
    s_add_u32 s34, s34, 49152
    s_add_u32 m0, s38, 110592
    s_nop 0
    buffer_load_dwordx4 v1, s[12:15], s32 offen lds
    s_add_u32 s32, s32, 61440
    s_add_u32 s34, s34, 49152
    s_add_u32 m0, s35, 32768
    s_nop 0
    buffer_load_dwordx4 v0, s[8:11], s30 offen lds
    s_add_u32 m0, s35, 33792
    s_add_u32 s31, s30, 10240
    buffer_load_dwordx4 v8, s[8:11], s31 offen lds
    s_add_u32 m0, s35, 34816
    s_add_u32 s31, s30, 20480
    buffer_load_dwordx4 v0, s[8:11], s31 offen lds
    s_add_u32 m0, s35, 35840
    s_add_u32 s31, s30, 30720
    buffer_load_dwordx4 v8, s[8:11], s31 offen lds
    s_add_u32 m0, s35, 36864
    s_add_u32 s31, s30, 40960
    buffer_load_dwordx4 v0, s[8:11], s31 offen lds
    s_add_u32 m0, s35, 37888
    s_add_u32 s31, s30, 51200
    buffer_load_dwordx4 v8, s[8:11], s31 offen lds
    s_add_u32 m0, s35, 38912
    s_add_u32 s31, s30, 61440
    buffer_load_dwordx4 v0, s[8:11], s31 offen lds
    s_add_u32 s30, s30, 128
    s_waitcnt vmcnt(11)
    s_barrier
    s_add_u32 m0, s38, 114688
    s_nop 0
    buffer_load_dwordx4 v1, s[12:15], s32 offen lds
    s_add_u32 s32, s32, 61440
    s_add_u32 s34, s34, 49152
    s_add_u32 m0, s38, 65536
    s_nop 0
    buffer_load_dwordx4 v1, s[12:15], s32 offen lds
    s_add_u32 s32, s32, 61440
    s_add_u32 s34, s34, 49152
    s_add_u32 m0, s38, 69632
    s_nop 0
    buffer_load_dwordx4 v1, s[12:15], s32 offen lds
    s_add_u32 s32, s32, 61440
    s_add_u32 s34, s34, 49152
    s_add_u32 m0, s38, 73728
    s_nop 0
    buffer_load_dwordx4 v1, s[12:15], s32 offen lds
    s_add_u32 s32, s32, 61440
    s_add_u32 s34, s34, 49152
    s_add_u32 m0, s35, 49152
    s_nop 0
    buffer_load_dwordx4 v0, s[8:11], s30 offen lds
    s_add_u32 m0, s35, 50176
    s_add_u32 s31, s30, 10240
    buffer_load_dwordx4 v8, s[8:11], s31 offen lds
    s_add_u32 m0, s35, 51200
    s_add_u32 s31, s30, 20480
    buffer_load_dwordx4 v0, s[8:11], s31 offen lds
    s_add_u32 m0, s35, 52224
    s_add_u32 s31, s30, 30720
    buffer_load_dwordx4 v8, s[8:11], s31 offen lds
    s_add_u32 m0, s35, 53248
    s_add_u32 s31, s30, 40960
    buffer_load_dwordx4 v0, s[8:11], s31 offen lds
    s_add_u32 m0, s35, 54272
    s_add_u32 s31, s30, 51200
    buffer_load_dwordx4 v8, s[8:11], s31 offen lds
    s_add_u32 m0, s35, 55296
    s_add_u32 s31, s30, 61440
    buffer_load_dwordx4 v0, s[8:11], s31 offen lds
    s_add_u32 s30, s30, 128
    s_waitcnt vmcnt(11)
    s_barrier
    s_add_u32 m0, s38, 77824
    s_nop 0
    buffer_load_dwordx4 v1, s[12:15], s32 offen lds
    s_add_u32 s32, s32, 61440
    s_add_u32 s34, s34, 49152
    s_add_u32 m0, s38, 81920
    s_nop 0
    buffer_load_dwordx4 v1, s[12:15], s32 offen lds
    s_add_u32 s32, s32, 61440
    s_add_u32 s34, s34, 49152
    s_add_u32 m0, s38, 86016
    s_nop 0
    buffer_load_dwordx4 v1, s[12:15], s32 offen lds
    s_add_u32 s32, s32, 61440
    s_add_u32 s34, s34, 49152
    s_add_u32 m0, s38, 90112
    s_nop 0
    buffer_load_dwordx4 v1, s[12:15], s32 offen lds
    s_add_u32 s32, s32, 61440
    s_add_u32 s34, s34, 49152
    s_add_u32 m0, s35, 0
    s_nop 0
    buffer_load_dwordx4 v0, s[8:11], s30 offen lds
    s_add_u32 m0, s35, 1024
    s_add_u32 s31, s30, 10240
    buffer_load_dwordx4 v8, s[8:11], s31 offen lds
    s_add_u32 m0, s35, 2048
    s_add_u32 s31, s30, 20480
    buffer_load_dwordx4 v0, s[8:11], s31 offen lds
    s_add_u32 m0, s35, 3072
    s_add_u32 s31, s30, 30720
    buffer_load_dwordx4 v8, s[8:11], s31 offen lds
    s_add_u32 m0, s35, 4096
    s_add_u32 s31, s30, 40960
    buffer_load_dwordx4 v0, s[8:11], s31 offen lds
    s_add_u32 m0, s35, 5120
    s_add_u32 s31, s30, 51200
    buffer_load_dwordx4 v8, s[8:11], s31 offen lds
    s_add_u32 m0, s35, 6144
    s_add_u32 s31, s30, 61440
    buffer_load_dwordx4 v0, s[8:11], s31 offen lds
    s_add_u32 s30, s30, 128
    s_waitcnt vmcnt(11)
    s_barrier
    s_add_u32 m0, s38, 94208
    s_nop 0
    buffer_load_dwordx4 v1, s[12:15], s32 offen lds
    s_add_u32 s32, s32, 61440
    s_add_u32 s34, s34, 49152
    s_add_u32 m0, s38, 98304
    s_nop 0
    buffer_load_dwordx4 v1, s[12:15], s32 offen lds
    s_add_u32 s32, s32, 61440
    s_add_u32 s34, s34, 49152
    s_add_u32 m0, s38, 102400
    s_nop 0
    buffer_load_dwordx4 v1, s[12:15], s32 offen lds
    s_add_u32 s32, s32, 61440
    s_add_u32 s34, s34, 49152
    s_add_u32 m0, s38, 106496
    s_nop 0
    buffer_load_dwordx4 v1, s[12:15], s32 offen lds
    s_add_u32 s32, s32, 61440
    s_add_u32 s34, s34, 49152
    s_add_u32 m0, s35, 16384
    s_nop 0
    buffer_load_dwordx4 v0, s[8:11], s30 offen lds
    s_add_u32 m0, s35, 17408
    s_add_u32 s31, s30, 10240
    buffer_load_dwordx4 v8, s[8:11], s31 offen lds
    s_add_u32 m0, s35, 18432
    s_add_u32 s31, s30, 20480
    buffer_load_dwordx4 v0, s[8:11], s31 offen lds
    s_add_u32 m0, s35, 19456
    s_add_u32 s31, s30, 30720
    buffer_load_dwordx4 v8, s[8:11], s31 offen lds
    s_add_u32 m0, s35, 20480
    s_add_u32 s31, s30, 40960
    buffer_load_dwordx4 v0, s[8:11], s31 offen lds
    s_add_u32 m0, s35, 21504
    s_add_u32 s31, s30, 51200
    buffer_load_dwordx4 v8, s[8:11], s31 offen lds
    s_add_u32 m0, s35, 22528
    s_add_u32 s31, s30, 61440
    buffer_load_dwordx4 v0, s[8:11], s31 offen lds
    s_add_u32 s30, s30, 128
    s_waitcnt vmcnt(11)
    s_barrier
    s_add_u32 m0, s38, 110592
    s_nop 0
    buffer_load_dwordx4 v1, s[12:15], s32 offen lds
    s_add_u32 s32, s32, 61440
    s_add_u32 s34, s34, 49152
    s_add_u32 m0, s38, 114688
    s_nop 0
    buffer_load_dwordx4 v1, s[12:15], s32 offen lds
    s_add_u32 s32, s32, 61440
    s_add_u32 s34, s34, 49152
    s_add_u32 m0, s38, 65536
    s_nop 0
    buffer_load_dwordx4 v1, s[12:15], s32 offen lds
    s_add_u32 s32, s32, 61440
    s_add_u32 s34, s34, 49152
    s_waitcnt vmcnt(3)
    s_barrier
    s_waitcnt vmcnt(0)
    s_barrier
    s_load_dwordx2 s[48:49], s[0:1], 48
    s_load_dwordx2 s[50:51], s[0:1], 16
    s_lshl_b32 s36, s2, 2
    s_add_u32 s36, s36, s29
    s_mul_i32 s36, s36, 3
    s_mul_i32 s37, s29, 3072
    v_lshrrev_b32 v5, 2, v4
    v_mul_u32_u24 v0, 1280, v5
    v_and_b32 v6, 3, v4
    v_lshl_add_u32 v0, v6, 4, v0
    v_lshrrev_b32 v5, 4, v4
    v_mul_u32_u24 v5, 20, v5
    v_bfe_u32 v6, v4, 2, 2
    v_add_u32 v5, v5, v6
    v_mul_u32_u24 v3, 1280, v5
    v_and_b32 v6, 3, v4
    v_lshl_add_u32 v3, v6, 4, v3
    v_lshrrev_b32 v5, 5, v4
    v_bfe_u32 v6, v4, 2, 2
    v_lshl_add_u32 v5, v5, 3, v6
    v_lshlrev_b32 v5, 6, v5
    v_bfe_u32 v6, v4, 4, 1
    v_lshl_add_u32 v5, v6, 5, v5
    v_and_b32 v6, 3, v4
    v_lshl_add_u32 v1, v6, 3, v5
    v_add_u32 v1, s37, v1
    v_lshlrev_b32 v2, 4, v4
    s_waitcnt lgkmcnt(0)
    s_add_u32 s38, s36, 0
    s_min_u32 s38, s38, 2719
    s_mul_hi_u32 s39, s38, 0x0ccccccd
    s_mul_i32 s40, s39, 20
    s_sub_u32 s40, s38, s40
    s_cmp_ge_u32 s39, 96
    s_cselect_b32 s52, s50, s48
    s_cselect_b32 s53, s51, s49
    s_mov_b32 s54, 1966080
    s_cselect_b32 s54, 819200, s54
    s_mov_b32 s55, 0x20000
    s_cselect_b32 s41, 96, 0
    s_mov_b32 s42, 96
    s_cselect_b32 s42, 40, s42
    s_mov_b32 s43, 19406848
    s_cselect_b32 s43, 21372928, s43
    s_sub_u32 s41, s39, s41
    s_mul_i32 s42, s42, s40
    s_add_u32 s42, s42, s41
    s_lshl_b32 s42, s42, 10
    s_add_u32 s56, s42, s43
    s_cmp_ge_u32 s39, 96
    s_cselect_b32 s46, 20, 16
    s_mul_i32 s47, s41, s46
    s_cmp_ge_u32 s39, 128
    s_cselect_b32 s46, 1, 0
    s_sub_u32 s45, s39, 128
    s_mul_i32 s45, s45, 80
    s_add_u32 s45, s45, 16
    s_cmp_eq_u32 s46, 1
    s_cselect_b32 s47, s45, s47
    s_mul_i32 s41, s47, 1280
    s_lshl_b32 s40, s40, 6
    s_add_u32 s41, s41, s40
    s_add_u32 m0, s37, 0
    s_cmp_eq_u32 s46, 1
    s_cbranch_scc1 L_wt_tail_b0
    buffer_load_dwordx4 v0, s[52:55], s41 offen lds
    s_branch L_wt_next_b0
L_wt_tail_b0:
    buffer_load_dwordx4 v3, s[52:55], s41 offen lds
L_wt_next_b0:
    s_add_u32 s38, s36, 1
    s_min_u32 s38, s38, 2719
    s_mul_hi_u32 s39, s38, 0x0ccccccd
    s_mul_i32 s40, s39, 20
    s_sub_u32 s40, s38, s40
    s_cmp_ge_u32 s39, 96
    s_cselect_b32 s52, s50, s48
    s_cselect_b32 s53, s51, s49
    s_mov_b32 s54, 1966080
    s_cselect_b32 s54, 819200, s54
    s_mov_b32 s55, 0x20000
    s_cselect_b32 s41, 96, 0
    s_mov_b32 s42, 96
    s_cselect_b32 s42, 40, s42
    s_mov_b32 s43, 19406848
    s_cselect_b32 s43, 21372928, s43
    s_sub_u32 s41, s39, s41
    s_mul_i32 s42, s42, s40
    s_add_u32 s42, s42, s41
    s_lshl_b32 s42, s42, 10
    s_add_u32 s57, s42, s43
    s_cmp_ge_u32 s39, 96
    s_cselect_b32 s46, 20, 16
    s_mul_i32 s47, s41, s46
    s_cmp_ge_u32 s39, 128
    s_cselect_b32 s46, 1, 0
    s_sub_u32 s45, s39, 128
    s_mul_i32 s45, s45, 80
    s_add_u32 s45, s45, 16
    s_cmp_eq_u32 s46, 1
    s_cselect_b32 s47, s45, s47
    s_mul_i32 s41, s47, 1280
    s_lshl_b32 s40, s40, 6
    s_add_u32 s41, s41, s40
    s_add_u32 m0, s37, 1024
    s_cmp_eq_u32 s46, 1
    s_cbranch_scc1 L_wt_tail_b1
    buffer_load_dwordx4 v0, s[52:55], s41 offen lds
    s_branch L_wt_next_b1
L_wt_tail_b1:
    buffer_load_dwordx4 v3, s[52:55], s41 offen lds
L_wt_next_b1:
    s_add_u32 s38, s36, 2
    s_min_u32 s38, s38, 2719
    s_mul_hi_u32 s39, s38, 0x0ccccccd
    s_mul_i32 s40, s39, 20
    s_sub_u32 s40, s38, s40
    s_cmp_ge_u32 s39, 96
    s_cselect_b32 s52, s50, s48
    s_cselect_b32 s53, s51, s49
    s_mov_b32 s54, 1966080
    s_cselect_b32 s54, 819200, s54
    s_mov_b32 s55, 0x20000
    s_cselect_b32 s41, 96, 0
    s_mov_b32 s42, 96
    s_cselect_b32 s42, 40, s42
    s_mov_b32 s43, 19406848
    s_cselect_b32 s43, 21372928, s43
    s_sub_u32 s41, s39, s41
    s_mul_i32 s42, s42, s40
    s_add_u32 s42, s42, s41
    s_lshl_b32 s42, s42, 10
    s_add_u32 s58, s42, s43
    s_cmp_ge_u32 s39, 96
    s_cselect_b32 s46, 20, 16
    s_mul_i32 s47, s41, s46
    s_cmp_ge_u32 s39, 128
    s_cselect_b32 s46, 1, 0
    s_sub_u32 s45, s39, 128
    s_mul_i32 s45, s45, 80
    s_add_u32 s45, s45, 16
    s_cmp_eq_u32 s46, 1
    s_cselect_b32 s47, s45, s47
    s_mul_i32 s41, s47, 1280
    s_lshl_b32 s40, s40, 6
    s_add_u32 s41, s41, s40
    s_add_u32 m0, s37, 2048
    s_cmp_eq_u32 s46, 1
    s_cbranch_scc1 L_wt_tail_b2
    buffer_load_dwordx4 v0, s[52:55], s41 offen lds
    s_branch L_wt_next_b2
L_wt_tail_b2:
    buffer_load_dwordx4 v3, s[52:55], s41 offen lds
L_wt_next_b2:
    s_waitcnt vmcnt(2)
    ds_read_b64_tr_b16 v[16:17], v1 offset:0
    ds_read_b64_tr_b16 v[18:19], v1 offset:256
    s_waitcnt vmcnt(1)
    ds_read_b64_tr_b16 v[20:21], v1 offset:1024
    ds_read_b64_tr_b16 v[22:23], v1 offset:1280
    s_waitcnt vmcnt(0)
    ds_read_b64_tr_b16 v[24:25], v1 offset:2048
    ds_read_b64_tr_b16 v[26:27], v1 offset:2304
    s_waitcnt lgkmcnt(4)
    buffer_store_dwordx4 v[16:19], v2, s[4:7], s56 offen nt
    s_waitcnt lgkmcnt(2)
    buffer_store_dwordx4 v[20:23], v2, s[4:7], s57 offen nt
    s_waitcnt lgkmcnt(0)
    buffer_store_dwordx4 v[24:27], v2, s[4:7], s58 offen nt
    s_endpgm
L_k1_end:
    s_endpgm
.globl attn_kernel
.p2align 8
.type attn_kernel,@function
attn_kernel:
    s_cmp_ge_u32 s2, 256
    s_cbranch_scc1 L_attn_end
    s_load_dwordx2 s[4:5], s[0:1], 80
    s_load_dwordx2 s[48:49], s[0:1], 64
    s_load_dwordx2 s[52:53], s[0:1], 72
    v_lshrrev_b32 v1, 6, v0
    s_and_b32 s9, s2, 7
    s_lshr_b32 s16, s2, 3
    v_readfirstlane_b32 s8, v1
    s_lshr_b32 s10, s16, 3
    s_lshl_b32 s11, s9, 2
    s_add_u32 s10, s10, s11
    s_and_b32 s11, s16, 7
    s_mul_i32 s15, s10, 81920
    s_cmp_ge_u32 s8, 8
    s_cbranch_scc1 L_attn_prod
    v_and_b32 v143, 63, v0
    v_lshlrev_b32 v148, 4, v0
    v_lshlrev_b32 v144, 4, v143
    s_and_b32 s12, s8, 3
    s_lshr_b32 s13, s8, 2
    s_lshl_b32 s14, s11, 3
    s_lshl_b32 s17, s12, 1
    s_add_u32 s14, s14, s17
    s_lshl_b32 s16, s14, 8
    s_mul_i32 s17, s10, 81920
    s_add_u32 s16, s16, s17
    s_add_u32 s16, s16, 0
    s_add_u32 s17, s16, 16384
    s_add_u32 s18, s16, 65536
    v_lshrrev_b32 v145, 5, v143
    v_and_b32 v146, 31, v143
    v_lshlrev_b32 v147, 3, v146
    v_lshl_add_u32 v138, v145, 15, v147
    s_waitcnt lgkmcnt(0)
    s_mov_b32 s6, 22194176
    s_mov_b32 s7, 0x20000
    buffer_load_dwordx2 v[112:113], v138, s[4:7], s16 offen offset:0
    buffer_load_dwordx2 v[114:115], v138, s[4:7], s17 offen offset:0
    buffer_load_dwordx2 v[120:121], v147, s[4:7], s18 offen offset:0
    buffer_load_dwordx2 v[116:117], v138, s[4:7], s16 offen offset:256
    buffer_load_dwordx2 v[118:119], v138, s[4:7], s17 offen offset:256
    buffer_load_dwordx2 v[122:123], v147, s[4:7], s18 offen offset:256
    v_min_u32 v148, 5616, v148
    v_add_u32 v148, 61440, v148
    v_mov_b32 v0, 0x3f803f80
    v_mov_b32 v1, 0x3f803f80
    v_mov_b32 v2, 0x3f803f80
    v_mov_b32 v3, 0x3f803f80
    ds_write_b128 v148, v[0:3]
    v_mov_b32 v8, 0
    v_mov_b32 v9, 0
    v_mov_b32 v10, 0
    v_mov_b32 v11, 0
    v_add_u32 v12, 87552, v148
    ds_write_b128 v12, v[8:11]
    s_mul_i32 s19, s13, 5120
    v_lshl_add_u32 v124, v145, 11, v147
    v_mov_b32 v130, v124
    v_add_u32 v139, 4096, v147
    v_mov_b32 v148, v139
    v_add_u32 v139, s19, v139
    v_cmp_eq_u32 vcc, 0, v145
    v_mov_b32 v4, 148992
    v_mov_b32 v5, 12
    v_cndmask_b32 v139, v4, v139, vcc
    v_cndmask_b32 v148, v4, v148, vcc
    v_cndmask_b32 v141, 0, -1, vcc
    v_cndmask_b32 v5, 0, v5, vcc
    v_mul_u32_u24 v140, 320, v145
    v_lshl_add_u32 v140, v146, 4, v140
    s_add_u32 s19, s19, 10240
    v_add_u32 v140, s19, v140
    v_lshlrev_b32 v147, 2, v145
    v_add_u32 v147, 4, v147
    v_cmp_lt_u32 vcc, 27, v146
    s_nop 1
    v_cndmask_b32 v147, v147, v5, vcc
    v_lshlrev_b32 v147, 4, v147
    v_add_u32 v147, 61440, v147
    v_cmp_lt_u32 vcc, 20, v146
    v_add_u32 v12, 87568, v147
    s_nop 0
    v_cndmask_b32 v147, v147, v12, vcc
    v_cmp_gt_u32 vcc, 20, v146
    s_nop 1
    v_cndmask_b32 v140, v147, v140, vcc
    v_cndmask_b32 v142, 0, -1, vcc
    v_mov_b32 v80, 0
    v_mov_b32 v81, 0
    v_mov_b32 v82, 0
    v_mov_b32 v83, 0
    v_mov_b32 v84, 0
    v_mov_b32 v85, 0
    v_mov_b32 v86, 0
    v_mov_b32 v87, 0
    v_mov_b32 v88, 0
    v_mov_b32 v89, 0
    v_mov_b32 v90, 0
    v_mov_b32 v91, 0
    v_mov_b32 v92, 0
    v_mov_b32 v93, 0
    v_mov_b32 v94, 0
    v_mov_b32 v95, 0
    v_mov_b32 v96, 0
    v_mov_b32 v97, 0
    v_mov_b32 v98, 0
    v_mov_b32 v99, 0
    v_mov_b32 v100, 0
    v_mov_b32 v101, 0
    v_mov_b32 v102, 0
    v_mov_b32 v103, 0
    v_mov_b32 v104, 0
    v_mov_b32 v105, 0
    v_mov_b32 v106, 0
    v_mov_b32 v107, 0
    v_mov_b32 v108, 0
    v_mov_b32 v109, 0
    v_mov_b32 v110, 0
    v_mov_b32 v111, 0
    v_mov_b32 v76, 0
    v_mov_b32 v77, 0
    v_mov_b32 v78, 0
    v_mov_b32 v79, 0
    v_mov_b32 v134, 0
    v_mov_b32 v135, 0
    v_mov_b32 v136, 0
    v_mov_b32 v137, 0
    s_waitcnt vmcnt(0) lgkmcnt(0)
    s_mul_i32 s19, s13, 5120
    v_add_u32 v138, s19, v130
    s_mov_b32 exec_lo, 0
    v_mov_b32 v120, 0
    v_mov_b32 v121, 0
    v_mov_b32 v122, 0
    v_mov_b32 v123, 0
    s_mov_b64 exec, -1
    s_barrier
    ds_read2_b64 v[124:127], v138 offset0:0 offset1:128
    ds_read_b64 v[128:129], v139 offset:0
    s_waitcnt lgkmcnt(0)
    v_mfma_f32_32x32x16_bf16 v[0:15], v[124:127], v[112:115], 0
    v_mfma_f32_32x32x16_bf16 v[16:31], v[124:127], v[116:119], 0
    v_mfma_f32_32x32x8_bf16 v[0:15], v[128:129], v[120:121], v[0:15]
    v_mfma_f32_32x32x8_bf16 v[16:31], v[128:129], v[122:123], v[16:31]
    ds_read2_b64 v[124:127], v138 offset0:32 offset1:160
    ds_read_b64 v[128:129], v139 offset:256
    ds_read_b128 v[130:133], v140 offset:0
    s_nop 9
    s_mov_b32 s20, 0
    s_mov_b32 s28, 0
L_attn_loop:
    s_mov_b32 s21, 20480
    s_add_u32 s28, s28, 1
    s_cmp_eq_u32 s28, 3
    s_cselect_b32 s21, 4294926336, s21
    s_cselect_b32 s28, 0, s28
    s_waitcnt lgkmcnt(0)
    v_mfma_f32_32x32x16_bf16 v[32:47], v[124:127], v[112:115], 0
    v_exp_f32 v0, v0
    v_exp_f32 v1, v1
    v_exp_f32 v2, v2
    v_exp_f32 v3, v3
    v_mfma_f32_32x32x16_bf16 v[96:111], v[134:137], v[76:79], v[96:111]
    ds_read_b128 v[134:137], v140 offset:640
    v_exp_f32 v4, v4
    v_exp_f32 v5, v5
    v_exp_f32 v6, v6
    v_exp_f32 v7, v7
    v_mfma_f32_32x32x16_bf16 v[48:63], v[124:127], v[116:119], 0
    v_cvt_pk_bf16_f32 v64, v0, v1
    v_cvt_pk_bf16_f32 v65, v2, v3
    v_cvt_pk_bf16_f32 v66, v4, v5
    v_cvt_pk_bf16_f32 v67, v6, v7
    v_exp_f32 v16, v16
    v_exp_f32 v17, v17
    v_mfma_f32_32x32x16_bf16 v[80:95], v[130:133], v[64:67], v[80:95]
    v_exp_f32 v18, v18
    v_exp_f32 v19, v19
    v_exp_f32 v20, v20
    v_exp_f32 v21, v21
    v_mfma_f32_32x32x8_bf16 v[32:47], v[128:129], v[120:121], v[32:47]
    v_exp_f32 v22, v22
    v_exp_f32 v23, v23
    v_cvt_pk_bf16_f32 v72, v16, v17
    v_cvt_pk_bf16_f32 v73, v18, v19
    v_cvt_pk_bf16_f32 v74, v20, v21
    v_cvt_pk_bf16_f32 v75, v22, v23
    v_exp_f32 v8, v8
    v_exp_f32 v9, v9
    v_mfma_f32_32x32x16_bf16 v[96:111], v[130:133], v[72:75], v[96:111]
    ds_read_b128 v[130:133], v140 offset:1280
    v_exp_f32 v10, v10
    v_exp_f32 v11, v11
    v_exp_f32 v12, v12
    v_exp_f32 v13, v13
    v_mfma_f32_32x32x8_bf16 v[48:63], v[128:129], v[122:123], v[48:63]
    ds_read2_b64 v[124:127], v138 offset0:64 offset1:192
    ds_read_b64 v[128:129], v139 offset:512
    v_exp_f32 v14, v14
    v_exp_f32 v15, v15
    v_cvt_pk_bf16_f32 v68, v8, v9
    v_cvt_pk_bf16_f32 v69, v10, v11
    v_cvt_pk_bf16_f32 v70, v12, v13
    v_cvt_pk_bf16_f32 v71, v14, v15
    v_exp_f32 v24, v24
    v_exp_f32 v25, v25
    s_waitcnt lgkmcnt(3)
    v_mfma_f32_32x32x16_bf16 v[80:95], v[134:137], v[68:71], v[80:95]
    v_exp_f32 v26, v26
    v_exp_f32 v27, v27
    v_exp_f32 v28, v28
    v_exp_f32 v29, v29
    v_exp_f32 v30, v30
    v_exp_f32 v31, v31
    v_cvt_pk_bf16_f32 v76, v24, v25
    v_cvt_pk_bf16_f32 v77, v26, v27
    v_cvt_pk_bf16_f32 v78, v28, v29
    v_cvt_pk_bf16_f32 v79, v30, v31
    s_waitcnt lgkmcnt(0)
    v_mfma_f32_32x32x16_bf16 v[0:15], v[124:127], v[112:115], 0
    v_exp_f32 v32, v32
    v_exp_f32 v33, v33
    v_exp_f32 v34, v34
    v_exp_f32 v35, v35
    v_mfma_f32_32x32x16_bf16 v[96:111], v[134:137], v[76:79], v[96:111]
    ds_read_b128 v[134:137], v140 offset:1920
    v_exp_f32 v36, v36
    v_exp_f32 v37, v37
    v_exp_f32 v38, v38
    v_exp_f32 v39, v39
    v_mfma_f32_32x32x16_bf16 v[16:31], v[124:127], v[116:119], 0
    v_cvt_pk_bf16_f32 v64, v32, v33
    v_cvt_pk_bf16_f32 v65, v34, v35
    v_cvt_pk_bf16_f32 v66, v36, v37
    v_cvt_pk_bf16_f32 v67, v38, v39
    v_exp_f32 v48, v48
    v_exp_f32 v49, v49
    v_mfma_f32_32x32x16_bf16 v[80:95], v[130:133], v[64:67], v[80:95]
    v_exp_f32 v50, v50
    v_exp_f32 v51, v51
    v_exp_f32 v52, v52
    v_exp_f32 v53, v53
    v_mfma_f32_32x32x8_bf16 v[0:15], v[128:129], v[120:121], v[0:15]
    v_exp_f32 v54, v54
    v_exp_f32 v55, v55
    v_cvt_pk_bf16_f32 v72, v48, v49
    v_cvt_pk_bf16_f32 v73, v50, v51
    v_cvt_pk_bf16_f32 v74, v52, v53
    v_cvt_pk_bf16_f32 v75, v54, v55
    v_exp_f32 v40, v40
    v_exp_f32 v41, v41
    v_mfma_f32_32x32x16_bf16 v[96:111], v[130:133], v[72:75], v[96:111]
    ds_read_b128 v[130:133], v140 offset:2560
    v_exp_f32 v42, v42
    v_exp_f32 v43, v43
    v_exp_f32 v44, v44
    v_exp_f32 v45, v45
    v_mfma_f32_32x32x8_bf16 v[16:31], v[128:129], v[122:123], v[16:31]
    ds_read2_b64 v[124:127], v138 offset0:96 offset1:224
    ds_read_b64 v[128:129], v139 offset:768
    v_exp_f32 v46, v46
    v_exp_f32 v47, v47
    v_cvt_pk_bf16_f32 v68, v40, v41
    v_cvt_pk_bf16_f32 v69, v42, v43
    v_cvt_pk_bf16_f32 v70, v44, v45
    v_cvt_pk_bf16_f32 v71, v46, v47
    v_exp_f32 v56, v56
    v_exp_f32 v57, v57
    s_waitcnt lgkmcnt(3)
    v_mfma_f32_32x32x16_bf16 v[80:95], v[134:137], v[68:71], v[80:95]
    v_exp_f32 v58, v58
    v_exp_f32 v59, v59
    v_exp_f32 v60, v60
    v_exp_f32 v61, v61
    v_exp_f32 v62, v62
    v_exp_f32 v63, v63
    v_cvt_pk_bf16_f32 v76, v56, v57
    v_cvt_pk_bf16_f32 v77, v58, v59
    v_cvt_pk_bf16_f32 v78, v60, v61
    v_cvt_pk_bf16_f32 v79, v62, v63
    s_waitcnt lgkmcnt(0)
    v_mfma_f32_32x32x16_bf16 v[32:47], v[124:127], v[112:115], 0
    v_exp_f32 v0, v0
    v_exp_f32 v1, v1
    v_exp_f32 v2, v2
    v_exp_f32 v3, v3
    v_mfma_f32_32x32x16_bf16 v[96:111], v[134:137], v[76:79], v[96:111]
    ds_read_b128 v[134:137], v140 offset:3200
    v_exp_f32 v4, v4
    v_exp_f32 v5, v5
    v_exp_f32 v6, v6
    v_exp_f32 v7, v7
    v_mfma_f32_32x32x16_bf16 v[48:63], v[124:127], v[116:119], 0
    v_cvt_pk_bf16_f32 v64, v0, v1
    v_cvt_pk_bf16_f32 v65, v2, v3
    v_cvt_pk_bf16_f32 v66, v4, v5
    v_cvt_pk_bf16_f32 v67, v6, v7
    v_exp_f32 v16, v16
    v_exp_f32 v17, v17
    v_mfma_f32_32x32x16_bf16 v[80:95], v[130:133], v[64:67], v[80:95]
    v_exp_f32 v18, v18
    v_exp_f32 v19, v19
    v_exp_f32 v20, v20
    v_exp_f32 v21, v21
    v_mfma_f32_32x32x8_bf16 v[32:47], v[128:129], v[120:121], v[32:47]
    v_exp_f32 v22, v22
    v_exp_f32 v23, v23
    v_cvt_pk_bf16_f32 v72, v16, v17
    v_cvt_pk_bf16_f32 v73, v18, v19
    v_cvt_pk_bf16_f32 v74, v20, v21
    v_cvt_pk_bf16_f32 v75, v22, v23
    v_exp_f32 v8, v8
    v_exp_f32 v9, v9
    v_mfma_f32_32x32x16_bf16 v[96:111], v[130:133], v[72:75], v[96:111]
    ds_read_b128 v[130:133], v140 offset:3840
    v_exp_f32 v10, v10
    v_exp_f32 v11, v11
    v_exp_f32 v12, v12
    v_exp_f32 v13, v13
    v_mfma_f32_32x32x8_bf16 v[48:63], v[128:129], v[122:123], v[48:63]
    s_barrier
    v_and_b32 v145, s21, v141
    v_add_u32 v138, s21, v138
    v_add_u32 v139, v145, v139
    ds_read2_b64 v[124:127], v138 offset0:0 offset1:128
    ds_read_b64 v[128:129], v139 offset:0
    v_exp_f32 v14, v14
    v_exp_f32 v15, v15
    v_cvt_pk_bf16_f32 v68, v8, v9
    v_cvt_pk_bf16_f32 v69, v10, v11
    v_cvt_pk_bf16_f32 v70, v12, v13
    v_cvt_pk_bf16_f32 v71, v14, v15
    v_exp_f32 v24, v24
    v_exp_f32 v25, v25
    s_waitcnt lgkmcnt(3)
    v_mfma_f32_32x32x16_bf16 v[80:95], v[134:137], v[68:71], v[80:95]
    v_exp_f32 v26, v26
    v_exp_f32 v27, v27
    v_exp_f32 v28, v28
    v_exp_f32 v29, v29
    v_exp_f32 v30, v30
    v_exp_f32 v31, v31
    v_cvt_pk_bf16_f32 v76, v24, v25
    v_cvt_pk_bf16_f32 v77, v26, v27
    v_cvt_pk_bf16_f32 v78, v28, v29
    v_cvt_pk_bf16_f32 v79, v30, v31
    s_waitcnt lgkmcnt(0)
    v_mfma_f32_32x32x16_bf16 v[0:15], v[124:127], v[112:115], 0
    v_exp_f32 v32, v32
    v_exp_f32 v33, v33
    v_exp_f32 v34, v34
    v_exp_f32 v35, v35
    v_mfma_f32_32x32x16_bf16 v[96:111], v[134:137], v[76:79], v[96:111]
    ds_read_b128 v[134:137], v140 offset:4480
    v_exp_f32 v36, v36
    v_exp_f32 v37, v37
    v_exp_f32 v38, v38
    v_exp_f32 v39, v39
    v_mfma_f32_32x32x16_bf16 v[16:31], v[124:127], v[116:119], 0
    v_cvt_pk_bf16_f32 v64, v32, v33
    v_cvt_pk_bf16_f32 v65, v34, v35
    v_cvt_pk_bf16_f32 v66, v36, v37
    v_cvt_pk_bf16_f32 v67, v38, v39
    v_exp_f32 v48, v48
    v_exp_f32 v49, v49
    v_mfma_f32_32x32x16_bf16 v[80:95], v[130:133], v[64:67], v[80:95]
    v_exp_f32 v50, v50
    v_exp_f32 v51, v51
    v_exp_f32 v52, v52
    v_exp_f32 v53, v53
    v_mfma_f32_32x32x8_bf16 v[0:15], v[128:129], v[120:121], v[0:15]
    v_exp_f32 v54, v54
    v_exp_f32 v55, v55
    v_cvt_pk_bf16_f32 v72, v48, v49
    v_cvt_pk_bf16_f32 v73, v50, v51
    v_cvt_pk_bf16_f32 v74, v52, v53
    v_cvt_pk_bf16_f32 v75, v54, v55
    v_exp_f32 v40, v40
    v_exp_f32 v41, v41
    v_mfma_f32_32x32x16_bf16 v[96:111], v[130:133], v[72:75], v[96:111]
    v_and_b32 v145, s21, v142
    v_add_u32 v140, v145, v140
    ds_read_b128 v[130:133], v140 offset:0
    v_exp_f32 v42, v42
    v_exp_f32 v43, v43
    v_exp_f32 v44, v44
    v_exp_f32 v45, v45
    v_mfma_f32_32x32x8_bf16 v[16:31], v[128:129], v[122:123], v[16:31]
    ds_read2_b64 v[124:127], v138 offset0:32 offset1:160
    ds_read_b64 v[128:129], v139 offset:256
    v_exp_f32 v46, v46
    v_exp_f32 v47, v47
    v_cvt_pk_bf16_f32 v68, v40, v41
    v_cvt_pk_bf16_f32 v69, v42, v43
    v_cvt_pk_bf16_f32 v70, v44, v45
    v_cvt_pk_bf16_f32 v71, v46, v47
    v_exp_f32 v56, v56
    v_exp_f32 v57, v57
    s_waitcnt lgkmcnt(3)
    v_mfma_f32_32x32x16_bf16 v[80:95], v[134:137], v[68:71], v[80:95]
    v_exp_f32 v58, v58
    v_exp_f32 v59, v59
    v_exp_f32 v60, v60
    v_exp_f32 v61, v61
    v_exp_f32 v62, v62
    v_exp_f32 v63, v63
    v_cvt_pk_bf16_f32 v76, v56, v57
    v_cvt_pk_bf16_f32 v77, v58, v59
    v_cvt_pk_bf16_f32 v78, v60, v61
    v_cvt_pk_bf16_f32 v79, v62, v63
    s_add_u32 s20, s20, 1
    s_cmp_lt_u32 s20, 8
    s_cbranch_scc1 L_attn_loop
    s_setprio 0
    s_waitcnt lgkmcnt(0)
    v_mfma_f32_32x32x16_bf16 v[96:111], v[134:137], v[76:79], v[96:111]
    s_mul_i32 s19, s8, 3072
    s_cmp_ge_u32 s8, 6
    s_cselect_b32 s17, 22528, 0
    s_add_u32 s19, s19, s17
    v_add_u32 v145, s19, v144
    s_xor_b32 s18, s8, 4
    s_mul_i32 s19, s18, 3072
    s_cmp_ge_u32 s18, 6
    s_cselect_b32 s17, 22528, 0
    s_add_u32 s19, s19, s17
    v_add_u32 v146, s19, v144
    s_nop 7
    s_cmp_eq_u32 s13, 0
    s_cbranch_scc0 L_attn_kh1
    s_nop 3
    ds_write_b128 v145, v[96:99] offset:0
    ds_write_b128 v145, v[100:103] offset:1024
    ds_write_b128 v145, v[104:107] offset:2048
    s_waitcnt lgkmcnt(0)
    s_barrier
    ds_read_b128 v[0:3], v146 offset:0
    ds_read_b128 v[4:7], v146 offset:1024
    ds_read_b128 v[8:11], v146 offset:2048
    s_waitcnt lgkmcnt(0)
    v_add_f32 v80, v80, v0
    v_add_f32 v81, v81, v1
    v_add_f32 v82, v82, v2
    v_add_f32 v83, v83, v3
    v_add_f32 v84, v84, v4
    v_add_f32 v85, v85, v5
    v_add_f32 v86, v86, v6
    v_add_f32 v87, v87, v7
    v_add_f32 v88, v88, v8
    v_add_f32 v89, v89, v9
    v_add_f32 v90, v90, v10
    v_add_f32 v91, v91, v11
    s_add_u32 s25, s14, 0
    v_mov_b32 v145, v88
    v_mov_b32 v146, v88
    v_mov_b32 v147, 0x5d800000
    v_mov_b32 v148, 0x21800000
    v_permlane32_swap_b32 v145, v146
    s_nop 1
    v_cmp_nle_f32 vcc, v146, v147
    v_cmp_nge_f32 s[30:31], v146, v148
    s_nop 4
    s_or_b64 vcc, vcc, s[30:31]
    s_nop 4
    s_cbranch_vccz L_fin_ok0
    v_and_b32 v145, 31, v143
    v_lshrrev_b32 v146, 5, v143
    v_lshlrev_b32 v33, 3, v145
    v_lshl_add_u32 v32, v146, 15, v33
    v_min_u32 v145, 19, v145
    v_lshlrev_b32 v145, 4, v145
    v_mul_u32_u24 v34, 320, v146
    v_add_u32 v34, v34, v145
    v_mov_b32 v36, 0x3f803f80
    v_mov_b32 v35, 0xff800000
    s_mov_b32 exec_lo, 0
    v_mov_b32 v120, 0
    v_mov_b32 v121, 0
    s_mov_b64 exec, -1
    s_mul_i32 s30, s10, 81920
    s_add_u32 s30, s30, 2621440
    s_mov_b32 s32, 64
L_fb1_0:
    buffer_load_dwordx2 v[124:125], v32, s[4:7], s30 offen
    s_add_u32 s31, s30, 16384
    buffer_load_dwordx2 v[126:127], v32, s[4:7], s31 offen
    s_add_u32 s31, s30, 65536
    buffer_load_dwordx2 v[128:129], v33, s[4:7], s31 offen
    s_waitcnt vmcnt(0)
    s_mov_b32 exec_lo, 0
    v_mov_b32 v128, v36
    v_mov_b32 v129, v36
    s_mov_b64 exec, -1
    s_nop 4
    v_mfma_f32_32x32x16_bf16 v[0:15], v[124:127], v[112:115], 0
    v_mfma_f32_32x32x8_bf16 v[0:15], v[128:129], v[120:121], v[0:15]
    s_nop 15
    v_max3_f32 v35, v35, v0, v1
    v_max3_f32 v35, v35, v2, v3
    v_max3_f32 v35, v35, v4, v5
    v_max3_f32 v35, v35, v6, v7
    v_max3_f32 v35, v35, v8, v9
    v_max3_f32 v35, v35, v10, v11
    v_max3_f32 v35, v35, v12, v13
    v_max3_f32 v35, v35, v14, v15
    s_add_u32 s30, s30, 256
    s_sub_u32 s32, s32, 1
    s_cmp_lg_u32 s32, 0
    s_cbranch_scc1 L_fb1_0
    v_mov_b32 v145, v35
    v_mov_b32 v148, v35
    s_nop 1
    v_permlane32_swap_b32 v145, v148
    s_nop 1
    v_max_f32 v145, v145, v148
    v_sub_f32 v145, 0, v145
    v_and_b32 v146, 0xffff0000, v145
    v_sub_f32 v145, v145, v146
    v_and_b32 v147, 0xffff0000, v145
    v_sub_f32 v145, v145, v147
    v_lshrrev_b32 v146, 16, v146
    v_or_b32 v146, v146, v147
    v_lshrrev_b32 v145, 16, v145
    s_mov_b32 exec_lo, 0
    v_mov_b32 v120, v146
    v_mov_b32 v121, v145
    s_mov_b64 exec, -1
    v_mov_b32 v80, 0
    v_mov_b32 v81, 0
    v_mov_b32 v82, 0
    v_mov_b32 v83, 0
    v_mov_b32 v84, 0
    v_mov_b32 v85, 0
    v_mov_b32 v86, 0
    v_mov_b32 v87, 0
    v_mov_b32 v88, 0
    v_mov_b32 v89, 0
    v_mov_b32 v90, 0
    v_mov_b32 v91, 0
    v_mov_b32 v92, 0
    v_mov_b32 v93, 0
    v_mov_b32 v94, 0
    v_mov_b32 v95, 0
    s_mul_i32 s30, s10, 81920
    s_add_u32 s30, s30, 2621440
    s_add_u32 s33, s15, 5242880
    s_mov_b32 s32, 64
L_fb2_0:
    buffer_load_dwordx2 v[124:125], v32, s[4:7], s30 offen
    s_add_u32 s31, s30, 16384
    buffer_load_dwordx2 v[126:127], v32, s[4:7], s31 offen
    s_add_u32 s31, s30, 65536
    buffer_load_dwordx2 v[128:129], v33, s[4:7], s31 offen
    buffer_load_dwordx4 v[130:133], v34, s[4:7], s33 offen
    buffer_load_dwordx4 v[134:137], v34, s[4:7], s33 offen offset:640
    s_waitcnt vmcnt(0)
    s_mov_b32 exec_lo, 0
    v_mov_b32 v128, v36
    v_mov_b32 v129, v36
    s_mov_b64 exec, -1
    s_nop 4
    v_mfma_f32_32x32x16_bf16 v[0:15], v[124:127], v[112:115], 0
    v_mfma_f32_32x32x8_bf16 v[0:15], v[128:129], v[120:121], v[0:15]
    s_nop 15
    v_bfi_b32 v130, v142, v130, v36
    v_bfi_b32 v131, v142, v131, v36
    v_bfi_b32 v132, v142, v132, v36
    v_bfi_b32 v133, v142, v133, v36
    v_bfi_b32 v134, v142, v134, v36
    v_bfi_b32 v135, v142, v135, v36
    v_bfi_b32 v136, v142, v136, v36
    v_bfi_b32 v137, v142, v137, v36
    v_exp_f32 v0, v0
    v_exp_f32 v1, v1
    v_exp_f32 v2, v2
    v_exp_f32 v3, v3
    v_exp_f32 v4, v4
    v_exp_f32 v5, v5
    v_exp_f32 v6, v6
    v_exp_f32 v7, v7
    v_exp_f32 v8, v8
    v_exp_f32 v9, v9
    v_exp_f32 v10, v10
    v_exp_f32 v11, v11
    v_exp_f32 v12, v12
    v_exp_f32 v13, v13
    v_exp_f32 v14, v14
    v_exp_f32 v15, v15
    s_nop 0
    v_cvt_pk_bf16_f32 v64, v0, v1
    v_cvt_pk_bf16_f32 v65, v2, v3
    v_cvt_pk_bf16_f32 v66, v4, v5
    v_cvt_pk_bf16_f32 v67, v6, v7
    v_cvt_pk_bf16_f32 v68, v8, v9
    v_cvt_pk_bf16_f32 v69, v10, v11
    v_cvt_pk_bf16_f32 v70, v12, v13
    v_cvt_pk_bf16_f32 v71, v14, v15
    s_nop 1
    v_mfma_f32_32x32x16_bf16 v[80:95], v[130:133], v[64:67], v[80:95]
    v_mfma_f32_32x32x16_bf16 v[80:95], v[134:137], v[68:71], v[80:95]
    s_add_u32 s30, s30, 256
    s_add_u32 s33, s33, 1280
    s_sub_u32 s32, s32, 1
    s_cmp_lg_u32 s32, 0
    s_cbranch_scc1 L_fb2_0
    s_nop 15
L_fin_ok0:
    v_mov_b32 v145, v88
    v_mov_b32 v146, v88
    v_and_b32 v148, 31, v143
    v_lshlrev_b32 v148, 4, v148
    v_permlane32_swap_b32 v145, v146
    v_lshrrev_b32 v145, 5, v143
    v_lshl_add_u32 v148, v145, 15, v148
    v_rcp_f32 v147, v146
    s_lshl_b32 s26, s25, 9
    s_lshl_b32 s27, s10, 16
    s_add_u32 s26, s26, s27
    s_add_u32 s26, s26, 14155776
    s_lshl_b32 s27, s25, 8
    s_lshl_b32 s29, s10, 14
    s_add_u32 s27, s27, s29
    s_add_u32 s27, s27, 16252928
    v_mul_f32 v80, v80, v147
    v_mul_f32 v81, v81, v147
    v_mul_f32 v82, v82, v147
    v_mul_f32 v83, v83, v147
    v_mul_f32 v84, v84, v147
    v_mul_f32 v85, v85, v147
    v_mul_f32 v86, v86, v147
    v_mul_f32 v87, v87, v147
    v_mul_f32 v88, v88, v147
    v_mul_f32 v89, v89, v147
    v_mul_f32 v90, v90, v147
    v_mul_f32 v91, v91, v147
    v_cvt_pk_bf16_f32 v80, v80, v81
    v_cvt_pk_bf16_f32 v81, v82, v83
    v_cvt_pk_bf16_f32 v82, v84, v85
    v_cvt_pk_bf16_f32 v83, v86, v87
    v_cvt_pk_bf16_f32 v84, v88, v89
    v_cvt_pk_bf16_f32 v85, v90, v91
    v_lshlrev_b32 v145, 3, v143
    s_nop 0
    v_permlane32_swap_b32 v80, v82
    v_permlane32_swap_b32 v81, v83
    v_mov_b32_dpp v86, v84 quad_perm:[1,1,3,3] row_mask:0xf bank_mask:0xf
    v_mov_b32_dpp v87, v85 quad_perm:[1,1,3,3] row_mask:0xf bank_mask:0xf
    buffer_store_dwordx4 v[80:83], v148, s[4:7], s26 offen sc1
    s_mov_b32 exec_lo, 0x55555555
    s_mov_b32 exec_hi, 0
    buffer_store_dwordx4 v[84:87], v145, s[4:7], s27 offen sc1
    s_mov_b64 exec, -1
    s_branch L_attn_tail
L_attn_kh1:
    ds_write_b128 v145, v[80:83] offset:0
    ds_write_b128 v145, v[84:87] offset:1024
    ds_write_b128 v145, v[88:91] offset:2048
    s_waitcnt lgkmcnt(0)
    s_barrier
    ds_read_b128 v[0:3], v146 offset:0
    ds_read_b128 v[4:7], v146 offset:1024
    ds_read_b128 v[8:11], v146 offset:2048
    s_waitcnt lgkmcnt(0)
    v_add_f32 v96, v96, v0
    v_add_f32 v97, v97, v1
    v_add_f32 v98, v98, v2
    v_add_f32 v99, v99, v3
    v_add_f32 v100, v100, v4
    v_add_f32 v101, v101, v5
    v_add_f32 v102, v102, v6
    v_add_f32 v103, v103, v7
    v_add_f32 v104, v104, v8
    v_add_f32 v105, v105, v9
    v_add_f32 v106, v106, v10
    v_add_f32 v107, v107, v11
    s_add_u32 s25, s14, 1
    v_mov_b32 v145, v104
    v_mov_b32 v146, v104
    v_mov_b32 v147, 0x5d800000
    v_mov_b32 v148, 0x21800000
    v_permlane32_swap_b32 v145, v146
    s_nop 1
    v_cmp_nle_f32 vcc, v146, v147
    v_cmp_nge_f32 s[30:31], v146, v148
    s_nop 4
    s_or_b64 vcc, vcc, s[30:31]
    s_nop 4
    s_cbranch_vccz L_fin_ok1
    v_and_b32 v145, 31, v143
    v_lshrrev_b32 v146, 5, v143
    v_lshlrev_b32 v33, 3, v145
    v_lshl_add_u32 v32, v146, 15, v33
    v_min_u32 v145, 19, v145
    v_lshlrev_b32 v145, 4, v145
    v_mul_u32_u24 v34, 320, v146
    v_add_u32 v34, v34, v145
    v_mov_b32 v36, 0x3f803f80
    v_mov_b32 v35, 0xff800000
    s_mov_b32 exec_lo, 0
    v_mov_b32 v122, 0
    v_mov_b32 v123, 0
    s_mov_b64 exec, -1
    s_mul_i32 s30, s10, 81920
    s_add_u32 s30, s30, 2621440
    s_mov_b32 s32, 64
L_fb1_1:
    buffer_load_dwordx2 v[124:125], v32, s[4:7], s30 offen
    s_add_u32 s31, s30, 16384
    buffer_load_dwordx2 v[126:127], v32, s[4:7], s31 offen
    s_add_u32 s31, s30, 65536
    buffer_load_dwordx2 v[128:129], v33, s[4:7], s31 offen
    s_waitcnt vmcnt(0)
    s_mov_b32 exec_lo, 0
    v_mov_b32 v128, v36
    v_mov_b32 v129, v36
    s_mov_b64 exec, -1
    s_nop 4
    v_mfma_f32_32x32x16_bf16 v[0:15], v[124:127], v[116:119], 0
    v_mfma_f32_32x32x8_bf16 v[0:15], v[128:129], v[122:123], v[0:15]
    s_nop 15
    v_max3_f32 v35, v35, v0, v1
    v_max3_f32 v35, v35, v2, v3
    v_max3_f32 v35, v35, v4, v5
    v_max3_f32 v35, v35, v6, v7
    v_max3_f32 v35, v35, v8, v9
    v_max3_f32 v35, v35, v10, v11
    v_max3_f32 v35, v35, v12, v13
    v_max3_f32 v35, v35, v14, v15
    s_add_u32 s30, s30, 256
    s_sub_u32 s32, s32, 1
    s_cmp_lg_u32 s32, 0
    s_cbranch_scc1 L_fb1_1
    v_mov_b32 v145, v35
    v_mov_b32 v148, v35
    s_nop 1
    v_permlane32_swap_b32 v145, v148
    s_nop 1
    v_max_f32 v145, v145, v148
    v_sub_f32 v145, 0, v145
    v_and_b32 v146, 0xffff0000, v145
    v_sub_f32 v145, v145, v146
    v_and_b32 v147, 0xffff0000, v145
    v_sub_f32 v145, v145, v147
    v_lshrrev_b32 v146, 16, v146
    v_or_b32 v146, v146, v147
    v_lshrrev_b32 v145, 16, v145
    s_mov_b32 exec_lo, 0
    v_mov_b32 v122, v146
    v_mov_b32 v123, v145
    s_mov_b64 exec, -1
    v_mov_b32 v96, 0
    v_mov_b32 v97, 0
    v_mov_b32 v98, 0
    v_mov_b32 v99, 0
    v_mov_b32 v100, 0
    v_mov_b32 v101, 0
    v_mov_b32 v102, 0
    v_mov_b32 v103, 0
    v_mov_b32 v104, 0
    v_mov_b32 v105, 0
    v_mov_b32 v106, 0
    v_mov_b32 v107, 0
    v_mov_b32 v108, 0
    v_mov_b32 v109, 0
    v_mov_b32 v110, 0
    v_mov_b32 v111, 0
    s_mul_i32 s30, s10, 81920
    s_add_u32 s30, s30, 2621440
    s_add_u32 s33, s15, 5242880
    s_mov_b32 s32, 64
L_fb2_1:
    buffer_load_dwordx2 v[124:125], v32, s[4:7], s30 offen
    s_add_u32 s31, s30, 16384
    buffer_load_dwordx2 v[126:127], v32, s[4:7], s31 offen
    s_add_u32 s31, s30, 65536
    buffer_load_dwordx2 v[128:129], v33, s[4:7], s31 offen
    buffer_load_dwordx4 v[130:133], v34, s[4:7], s33 offen
    buffer_load_dwordx4 v[134:137], v34, s[4:7], s33 offen offset:640
    s_waitcnt vmcnt(0)
    s_mov_b32 exec_lo, 0
    v_mov_b32 v128, v36
    v_mov_b32 v129, v36
    s_mov_b64 exec, -1
    s_nop 4
    v_mfma_f32_32x32x16_bf16 v[0:15], v[124:127], v[116:119], 0
    v_mfma_f32_32x32x8_bf16 v[0:15], v[128:129], v[122:123], v[0:15]
    s_nop 15
    v_bfi_b32 v130, v142, v130, v36
    v_bfi_b32 v131, v142, v131, v36
    v_bfi_b32 v132, v142, v132, v36
    v_bfi_b32 v133, v142, v133, v36
    v_bfi_b32 v134, v142, v134, v36
    v_bfi_b32 v135, v142, v135, v36
    v_bfi_b32 v136, v142, v136, v36
    v_bfi_b32 v137, v142, v137, v36
    v_exp_f32 v0, v0
    v_exp_f32 v1, v1
    v_exp_f32 v2, v2
    v_exp_f32 v3, v3
    v_exp_f32 v4, v4
    v_exp_f32 v5, v5
    v_exp_f32 v6, v6
    v_exp_f32 v7, v7
    v_exp_f32 v8, v8
    v_exp_f32 v9, v9
    v_exp_f32 v10, v10
    v_exp_f32 v11, v11
    v_exp_f32 v12, v12
    v_exp_f32 v13, v13
    v_exp_f32 v14, v14
    v_exp_f32 v15, v15
    s_nop 0
    v_cvt_pk_bf16_f32 v64, v0, v1
    v_cvt_pk_bf16_f32 v65, v2, v3
    v_cvt_pk_bf16_f32 v66, v4, v5
    v_cvt_pk_bf16_f32 v67, v6, v7
    v_cvt_pk_bf16_f32 v68, v8, v9
    v_cvt_pk_bf16_f32 v69, v10, v11
    v_cvt_pk_bf16_f32 v70, v12, v13
    v_cvt_pk_bf16_f32 v71, v14, v15
    s_nop 1
    v_mfma_f32_32x32x16_bf16 v[96:111], v[130:133], v[64:67], v[96:111]
    v_mfma_f32_32x32x16_bf16 v[96:111], v[134:137], v[68:71], v[96:111]
    s_add_u32 s30, s30, 256
    s_add_u32 s33, s33, 1280
    s_sub_u32 s32, s32, 1
    s_cmp_lg_u32 s32, 0
    s_cbranch_scc1 L_fb2_1
    s_nop 15
L_fin_ok1:
    v_mov_b32 v145, v104
    v_mov_b32 v146, v104
    v_and_b32 v148, 31, v143
    v_lshlrev_b32 v148, 4, v148
    v_permlane32_swap_b32 v145, v146
    v_lshrrev_b32 v145, 5, v143
    v_lshl_add_u32 v148, v145, 15, v148
    v_rcp_f32 v147, v146
    s_lshl_b32 s26, s25, 9
    s_lshl_b32 s27, s10, 16
    s_add_u32 s26, s26, s27
    s_add_u32 s26, s26, 14155776
    s_lshl_b32 s27, s25, 8
    s_lshl_b32 s29, s10, 14
    s_add_u32 s27, s27, s29
    s_add_u32 s27, s27, 16252928
    v_mul_f32 v96, v96, v147
    v_mul_f32 v97, v97, v147
    v_mul_f32 v98, v98, v147
    v_mul_f32 v99, v99, v147
    v_mul_f32 v100, v100, v147
    v_mul_f32 v101, v101, v147
    v_mul_f32 v102, v102, v147
    v_mul_f32 v103, v103, v147
    v_mul_f32 v104, v104, v147
    v_mul_f32 v105, v105, v147
    v_mul_f32 v106, v106, v147
    v_mul_f32 v107, v107, v147
    v_cvt_pk_bf16_f32 v96, v96, v97
    v_cvt_pk_bf16_f32 v97, v98, v99
    v_cvt_pk_bf16_f32 v98, v100, v101
    v_cvt_pk_bf16_f32 v99, v102, v103
    v_cvt_pk_bf16_f32 v100, v104, v105
    v_cvt_pk_bf16_f32 v101, v106, v107
    v_lshlrev_b32 v145, 3, v143
    s_nop 0
    v_permlane32_swap_b32 v96, v98
    v_permlane32_swap_b32 v97, v99
    v_mov_b32_dpp v102, v100 quad_perm:[1,1,3,3] row_mask:0xf bank_mask:0xf
    v_mov_b32_dpp v103, v101 quad_perm:[1,1,3,3] row_mask:0xf bank_mask:0xf
    buffer_store_dwordx4 v[96:99], v148, s[4:7], s26 offen sc1
    s_mov_b32 exec_lo, 0x55555555
    s_mov_b32 exec_hi, 0
    buffer_store_dwordx4 v[100:103], v145, s[4:7], s27 offen sc1
    s_mov_b64 exec, -1
L_attn_tail:
    s_lshl_b32 s40, s11, 3
    s_and_b32 s19, s10, 7
    s_add_u32 s40, s40, s19
    s_lshr_b32 s41, s10, 3
    v_mbcnt_lo_u32_b32 v112, -1, 0
    v_mbcnt_hi_u32_b32 v112, -1, v112
    s_lshr_b32 s42, s8, 2
    s_mul_i32 s42, s42, 20
    s_and_b32 s43, s8, 3
    s_mul_i32 s19, s41, 5
    s_add_u32 s19, s19, s43
    s_mul_i32 s19, s19, 40
    s_add_u32 s19, s19, s42
    s_lshl_b32 s19, s19, 10
    s_add_u32 s44, s19, 21372928
    v_lshlrev_b32 v113, 4, v112
    s_barrier
    v_lshrrev_b32 v114, 5, v112
    v_lshlrev_b32 v114, 15, v114
    v_and_b32 v115, 31, v112
    v_lshl_add_u32 v114, v115, 4, v114
    s_lshl_b32 s45, s8, 16
    s_lshl_b32 s19, s40, 9
    s_add_u32 s45, s45, s19
    s_add_u32 s45, s45, 14155776
    s_add_u32 s47, s8, 4
    s_lshl_b32 s47, s47, 16
    s_lshl_b32 s19, s40, 8
    s_add_u32 s47, s47, s19
    s_add_u32 s47, s47, 16252928
    s_lshl_b32 s37, s8, 10
    v_lshlrev_b32 v115, 4, v112
    v_add_u32 v115, s37, v115
    s_mov_b32 s46, 4096
    s_mov_b32 s36, s45
    s_add_u32 m0, s37, 0
    s_nop 0
    buffer_load_dwordx4 v114, s[4:7], s36 offen sc1 lds
    s_add_u32 s36, s36, 786432
    s_add_u32 m0, s37, 12288
    s_nop 0
    buffer_load_dwordx4 v114, s[4:7], s36 offen sc1 lds
    s_add_u32 s36, s36, 786432
    s_add_u32 m0, s37, 24576
    s_nop 0
    buffer_load_dwordx4 v114, s[4:7], s36 offen sc1 lds
    s_add_u32 s36, s36, 786432
    s_cmp_lt_u32 s8, 4
    s_cbranch_scc0 L_odma_doneaa
    v_lshrrev_b32 v95, 4, v112
    v_lshlrev_b32 v95, 14, v95
    v_and_b32 v94, 15, v112
    v_lshl_add_u32 v95, v94, 4, v95
    s_add_u32 m0, s37, 36864
    s_nop 0
    buffer_load_dwordx4 v95, s[4:7], s47 offen sc1 lds
L_odma_doneaa:
    buffer_load_dwordx4 v[0:3], v113, s[4:7], s44 offen offset:0
    buffer_load_dwordx4 v[4:7], v113, s[4:7], s44 offen offset:1024
    buffer_load_dwordx4 v[8:11], v113, s[4:7], s44 offen offset:2048
    buffer_load_dwordx4 v[12:15], v113, s[4:7], s44 offen offset:3072
    s_add_u32 s44, s44, 4096
    buffer_load_dwordx4 v[16:19], v113, s[4:7], s44 offen offset:0
    buffer_load_dwordx4 v[20:23], v113, s[4:7], s44 offen offset:1024
    buffer_load_dwordx4 v[24:27], v113, s[4:7], s44 offen offset:2048
    buffer_load_dwordx4 v[28:31], v113, s[4:7], s44 offen offset:3072
    s_waitcnt vmcnt(8)
    s_branch L_ochka
L_oretrya:
    s_mov_b32 s36, s45
    s_add_u32 m0, s37, 0
    s_nop 0
    buffer_load_dwordx4 v114, s[4:7], s36 offen sc1 lds
    s_add_u32 s36, s36, 786432
    s_add_u32 m0, s37, 12288
    s_nop 0
    buffer_load_dwordx4 v114, s[4:7], s36 offen sc1 lds
    s_add_u32 s36, s36, 786432
    s_add_u32 m0, s37, 24576
    s_nop 0
    buffer_load_dwordx4 v114, s[4:7], s36 offen sc1 lds
    s_add_u32 s36, s36, 786432
    s_cmp_lt_u32 s8, 4
    s_cbranch_scc0 L_odma_doneab
    v_lshrrev_b32 v95, 4, v112
    v_lshlrev_b32 v95, 14, v95
    v_and_b32 v94, 15, v112
    v_lshl_add_u32 v95, v94, 4, v95
    s_add_u32 m0, s37, 36864
    s_nop 0
    buffer_load_dwordx4 v95, s[4:7], s47 offen sc1 lds
L_odma_doneab:
    s_waitcnt vmcnt(0)
L_ochka:
    ds_read_b128 v[80:83], v115 offset:0
    ds_read_b128 v[84:87], v115 offset:12288
    ds_read_b128 v[88:91], v115 offset:24576
    s_mov_b32 s19, 24576
    s_cmp_lt_u32 s8, 4
    s_cselect_b32 s19, 36864, s19
    v_add_u32 v92, s19, v115
    ds_read_b128 v[92:95], v92
    s_waitcnt lgkmcnt(0)
    v_max3_u32 v80, v80, v81, v82
    v_max3_u32 v80, v80, v83, v84
    v_max3_u32 v80, v80, v85, v86
    v_max3_u32 v80, v80, v87, v88
    v_max3_u32 v80, v80, v89, v90
    v_max3_u32 v80, v80, v91, v92
    v_max3_u32 v80, v80, v93, v94
    v_max_u32 v80, v80, v95
    v_cmp_eq_u32 vcc, -1, v80
    s_sub_u32 s46, s46, 1
    s_cmp_eq_u32 s46, 0
    s_cbranch_scc1 L_odonea
    s_nop 2
    s_cbranch_vccnz L_oretrya
L_odonea:
    s_waitcnt vmcnt(0)
    s_barrier
    s_cmp_lt_u32 s8, 4
    s_cbranch_scc0 L_au_1
    v_lshlrev_b32 v114, 4, v112
    v_and_b32 v115, 31, v112
    v_lshlrev_b32 v115, 3, v115
    v_lshrrev_b32 v96, 5, v112
    v_lshl_add_u32 v115, v96, 9, v115
    s_add_u32 s44, s44, 4096
    buffer_load_dwordx4 v[32:35], v113, s[4:7], s44 offen offset:0
    buffer_load_dwordx4 v[36:39], v113, s[4:7], s44 offen offset:1024
    buffer_load_dwordx4 v[40:43], v113, s[4:7], s44 offen offset:2048
    buffer_load_dwordx4 v[44:47], v113, s[4:7], s44 offen offset:3072
    s_add_u32 s44, s44, 4096
    buffer_load_dwordx4 v[48:51], v113, s[4:7], s44 offen offset:0
    buffer_load_dwordx4 v[52:55], v113, s[4:7], s44 offen offset:1024
    buffer_load_dwordx4 v[56:59], v113, s[4:7], s44 offen offset:2048
    buffer_load_dwordx4 v[60:63], v113, s[4:7], s44 offen offset:3072
    s_add_u32 s44, s44, 4096
    buffer_load_dwordx4 v[64:67], v113, s[4:7], s44 offen offset:0
    buffer_load_dwordx4 v[68:71], v113, s[4:7], s44 offen offset:1024
    buffer_load_dwordx4 v[72:75], v113, s[4:7], s44 offen offset:2048
    buffer_load_dwordx4 v[76:79], v113, s[4:7], s44 offen offset:3072
    ds_read_b128 v[80:83], v114 offset:0
    ds_read_b128 v[84:87], v114 offset:1024
    ds_read_b128 v[88:91], v114 offset:2048
    s_lshl_b32 s19, s8, 12
    s_add_u32 s19, s19, 40960
    v_add_u32 v113, s19, v113
    ds_read_b128 v[92:95], v114 offset:3072
    s_waitcnt lgkmcnt(3)
    v_mfma_f32_32x32x16_bf16 v[96:111], v[0:3], v[80:83], 0
    ds_read_b128 v[80:83], v114 offset:4096
    s_waitcnt lgkmcnt(3)
    v_mfma_f32_32x32x16_bf16 v[96:111], v[4:7], v[84:87], v[96:111]
    ds_read_b128 v[84:87], v114 offset:5120
    s_waitcnt lgkmcnt(3)
    v_mfma_f32_32x32x16_bf16 v[96:111], v[8:11], v[88:91], v[96:111]
    ds_read_b128 v[88:91], v114 offset:6144
    s_waitcnt lgkmcnt(3)
    v_mfma_f32_32x32x16_bf16 v[96:111], v[12:15], v[92:95], v[96:111]
    ds_read_b128 v[92:95], v114 offset:7168
    s_waitcnt lgkmcnt(3)
    v_mfma_f32_32x32x16_bf16 v[96:111], v[16:19], v[80:83], v[96:111]
    ds_read_b128 v[80:83], v114 offset:8192
    s_waitcnt lgkmcnt(3)
    v_mfma_f32_32x32x16_bf16 v[96:111], v[20:23], v[84:87], v[96:111]
    ds_read_b128 v[84:87], v114 offset:9216
    s_waitcnt lgkmcnt(3)
    v_mfma_f32_32x32x16_bf16 v[96:111], v[24:27], v[88:91], v[96:111]
    ds_read_b128 v[88:91], v114 offset:10240
    s_waitcnt lgkmcnt(3)
    v_mfma_f32_32x32x16_bf16 v[96:111], v[28:31], v[92:95], v[96:111]
    ds_read_b128 v[92:95], v114 offset:11264
    s_waitcnt vmcnt(11) lgkmcnt(3)
    v_mfma_f32_32x32x16_bf16 v[96:111], v[32:35], v[80:83], v[96:111]
    ds_read_b128 v[80:83], v114 offset:12288
    s_waitcnt vmcnt(10) lgkmcnt(3)
    v_mfma_f32_32x32x16_bf16 v[96:111], v[36:39], v[84:87], v[96:111]
    ds_read_b128 v[84:87], v114 offset:13312
    s_waitcnt vmcnt(9) lgkmcnt(3)
    v_mfma_f32_32x32x16_bf16 v[96:111], v[40:43], v[88:91], v[96:111]
    ds_read_b128 v[88:91], v114 offset:14336
    s_waitcnt vmcnt(8) lgkmcnt(3)
    v_mfma_f32_32x32x16_bf16 v[96:111], v[44:47], v[92:95], v[96:111]
    ds_read_b128 v[92:95], v114 offset:15360
    s_waitcnt vmcnt(7) lgkmcnt(3)
    v_mfma_f32_32x32x16_bf16 v[96:111], v[48:51], v[80:83], v[96:111]
    ds_read_b128 v[80:83], v114 offset:16384
    s_waitcnt vmcnt(6) lgkmcnt(3)
    v_mfma_f32_32x32x16_bf16 v[96:111], v[52:55], v[84:87], v[96:111]
    ds_read_b128 v[84:87], v114 offset:17408
    s_waitcnt vmcnt(5) lgkmcnt(3)
    v_mfma_f32_32x32x16_bf16 v[96:111], v[56:59], v[88:91], v[96:111]
    ds_read_b128 v[88:91], v114 offset:18432
    s_waitcnt vmcnt(4) lgkmcnt(3)
    v_mfma_f32_32x32x16_bf16 v[96:111], v[60:63], v[92:95], v[96:111]
    ds_read_b128 v[92:95], v114 offset:19456
    s_waitcnt vmcnt(3) lgkmcnt(3)
    v_mfma_f32_32x32x16_bf16 v[96:111], v[64:67], v[80:83], v[96:111]
    s_waitcnt vmcnt(2) lgkmcnt(2)
    v_mfma_f32_32x32x16_bf16 v[96:111], v[68:71], v[84:87], v[96:111]
    s_waitcnt vmcnt(1) lgkmcnt(1)
    v_mfma_f32_32x32x16_bf16 v[96:111], v[72:75], v[88:91], v[96:111]
    s_waitcnt vmcnt(0) lgkmcnt(0)
    v_mfma_f32_32x32x16_bf16 v[96:111], v[76:79], v[92:95], v[96:111]
    s_nop 15
    ds_write_b128 v113, v[96:99] offset:0
    ds_write_b128 v113, v[100:103] offset:1024
    ds_write_b128 v113, v[104:107] offset:2048
    ds_write_b128 v113, v[108:111] offset:3072
    s_waitcnt lgkmcnt(0)
    s_branch L_au_done
L_au_1:
    v_lshlrev_b32 v114, 4, v112
    v_and_b32 v115, 31, v112
    v_lshlrev_b32 v115, 3, v115
    v_lshrrev_b32 v96, 5, v112
    v_lshl_add_u32 v115, v96, 9, v115
    s_add_u32 s44, s44, 4096
    buffer_load_dwordx4 v[32:35], v113, s[4:7], s44 offen offset:0
    buffer_load_dwordx4 v[36:39], v113, s[4:7], s44 offen offset:1024
    buffer_load_dwordx4 v[40:43], v113, s[4:7], s44 offen offset:2048
    buffer_load_dwordx4 v[44:47], v113, s[4:7], s44 offen offset:3072
    s_add_u32 s44, s44, 4096
    buffer_load_dwordx4 v[48:51], v113, s[4:7], s44 offen offset:0
    buffer_load_dwordx4 v[52:55], v113, s[4:7], s44 offen offset:1024
    buffer_load_dwordx4 v[56:59], v113, s[4:7], s44 offen offset:2048
    buffer_load_dwordx4 v[60:63], v113, s[4:7], s44 offen offset:3072
    s_add_u32 s44, s44, 4096
    buffer_load_dwordx4 v[64:67], v113, s[4:7], s44 offen offset:0
    buffer_load_dwordx4 v[68:71], v113, s[4:7], s44 offen offset:1024
    buffer_load_dwordx4 v[72:75], v113, s[4:7], s44 offen offset:2048
    buffer_load_dwordx4 v[76:79], v113, s[4:7], s44 offen offset:3072
    ds_read_b128 v[80:83], v114 offset:20480
    ds_read_b128 v[84:87], v114 offset:21504
    ds_read_b128 v[88:91], v114 offset:22528
    s_lshl_b32 s19, s8, 12
    s_add_u32 s19, s19, 40960
    v_add_u32 v113, s19, v113
    ds_read_b128 v[92:95], v114 offset:23552
    s_waitcnt lgkmcnt(3)
    v_mfma_f32_32x32x16_bf16 v[96:111], v[0:3], v[80:83], 0
    ds_read_b128 v[80:83], v114 offset:24576
    s_waitcnt lgkmcnt(3)
    v_mfma_f32_32x32x16_bf16 v[96:111], v[4:7], v[84:87], v[96:111]
    ds_read_b128 v[84:87], v114 offset:25600
    s_waitcnt lgkmcnt(3)
    v_mfma_f32_32x32x16_bf16 v[96:111], v[8:11], v[88:91], v[96:111]
    ds_read_b128 v[88:91], v114 offset:26624
    s_waitcnt lgkmcnt(3)
    v_mfma_f32_32x32x16_bf16 v[96:111], v[12:15], v[92:95], v[96:111]
    ds_read_b128 v[92:95], v114 offset:27648
    s_waitcnt lgkmcnt(3)
    v_mfma_f32_32x32x16_bf16 v[96:111], v[16:19], v[80:83], v[96:111]
    ds_read_b128 v[80:83], v114 offset:28672
    s_waitcnt lgkmcnt(3)
    v_mfma_f32_32x32x16_bf16 v[96:111], v[20:23], v[84:87], v[96:111]
    ds_read_b128 v[84:87], v114 offset:29696
    s_waitcnt lgkmcnt(3)
    v_mfma_f32_32x32x16_bf16 v[96:111], v[24:27], v[88:91], v[96:111]
    ds_read_b128 v[88:91], v114 offset:30720
    s_waitcnt lgkmcnt(3)
    v_mfma_f32_32x32x16_bf16 v[96:111], v[28:31], v[92:95], v[96:111]
    ds_read_b128 v[92:95], v114 offset:31744
    s_waitcnt vmcnt(11) lgkmcnt(3)
    v_mfma_f32_32x32x16_bf16 v[96:111], v[32:35], v[80:83], v[96:111]
    ds_read_b64 v[80:81], v115 offset:32768
    ds_read_b64 v[82:83], v115 offset:33024
    s_waitcnt vmcnt(10) lgkmcnt(4)
    v_mfma_f32_32x32x16_bf16 v[96:111], v[36:39], v[84:87], v[96:111]
    ds_read_b64 v[84:85], v115 offset:33792
    ds_read_b64 v[86:87], v115 offset:34048
    s_waitcnt vmcnt(9) lgkmcnt(5)
    v_mfma_f32_32x32x16_bf16 v[96:111], v[40:43], v[88:91], v[96:111]
    ds_read_b64 v[88:89], v115 offset:34816
    ds_read_b64 v[90:91], v115 offset:35072
    s_waitcnt vmcnt(8) lgkmcnt(6)
    v_mfma_f32_32x32x16_bf16 v[96:111], v[44:47], v[92:95], v[96:111]
    ds_read_b64 v[92:93], v115 offset:35840
    ds_read_b64 v[94:95], v115 offset:36096
    s_waitcnt vmcnt(7) lgkmcnt(6)
    v_mfma_f32_32x32x16_bf16 v[96:111], v[48:51], v[80:83], v[96:111]
    ds_read_b64 v[80:81], v115 offset:36864
    ds_read_b64 v[82:83], v115 offset:37120
    s_waitcnt vmcnt(6) lgkmcnt(6)
    v_mfma_f32_32x32x16_bf16 v[96:111], v[52:55], v[84:87], v[96:111]
    ds_read_b64 v[84:85], v115 offset:37888
    ds_read_b64 v[86:87], v115 offset:38144
    s_waitcnt vmcnt(5) lgkmcnt(6)
    v_mfma_f32_32x32x16_bf16 v[96:111], v[56:59], v[88:91], v[96:111]
    ds_read_b64 v[88:89], v115 offset:38912
    ds_read_b64 v[90:91], v115 offset:39168
    s_waitcnt vmcnt(4) lgkmcnt(6)
    v_mfma_f32_32x32x16_bf16 v[96:111], v[60:63], v[92:95], v[96:111]
    ds_read_b64 v[92:93], v115 offset:39936
    ds_read_b64 v[94:95], v115 offset:40192
    s_waitcnt vmcnt(3) lgkmcnt(6)
    v_mfma_f32_32x32x16_bf16 v[96:111], v[64:67], v[80:83], v[96:111]
    s_waitcnt vmcnt(2) lgkmcnt(4)
    v_mfma_f32_32x32x16_bf16 v[96:111], v[68:71], v[84:87], v[96:111]
    s_waitcnt vmcnt(1) lgkmcnt(2)
    v_mfma_f32_32x32x16_bf16 v[96:111], v[72:75], v[88:91], v[96:111]
    s_waitcnt vmcnt(0) lgkmcnt(0)
    v_mfma_f32_32x32x16_bf16 v[96:111], v[76:79], v[92:95], v[96:111]
    s_nop 15
    ds_write_b128 v113, v[96:99] offset:0
    ds_write_b128 v113, v[100:103] offset:1024
    ds_write_b128 v113, v[104:107] offset:2048
    ds_write_b128 v113, v[108:111] offset:3072
    s_waitcnt lgkmcnt(0)
L_au_done:
    s_barrier
    s_endpgm
L_attn_prod:
    s_setprio 3
    v_and_b32 v158, 63, v0
    v_lshlrev_b32 v152, 4, v158
    s_sub_u32 s13, s8, 8
    s_and_b32 s19, s13, 1
    s_mul_i32 s22, s10, 81920
    s_lshl_b32 s24, s19, 13
    s_add_u32 s22, s22, s24
    s_add_u32 s22, s22, 2621440
    s_mul_i32 s24, s19, 40960
    s_add_u32 s24, s24, s15
    s_add_u32 s24, s24, 5242880
    s_cmp_lt_u32 s13, 2
    s_cselect_b32 s22, s22, s24
    s_mov_b32 s37, 1024
    s_cselect_b32 s37, 16384, s37
    s_mov_b32 s38, 5120
    s_cselect_b32 s38, 1024, s38
    s_mul_i32 s23, s13, 5120
    s_waitcnt lgkmcnt(0)
    s_mov_b32 s6, 22194176
    s_mov_b32 s7, 0x20000
    s_mov_b32 s50, 2621440
    s_mov_b32 s51, 0x20000
    s_mov_b32 s24, s22
    s_add_u32 m0, s23, 0
    s_nop 0
    buffer_load_dwordx4 v152, s[4:7], s24 offen lds
    s_add_u32 m0, s23, 1024
    s_add_u32 s24, s24, s37
    buffer_load_dwordx4 v152, s[4:7], s24 offen lds
    s_add_u32 m0, s23, 2048
    s_add_u32 s24, s24, s37
    buffer_load_dwordx4 v152, s[4:7], s24 offen lds
    s_add_u32 m0, s23, 3072
    s_add_u32 s24, s24, s37
    buffer_load_dwordx4 v152, s[4:7], s24 offen lds
    s_add_u32 m0, s23, 4096
    s_add_u32 s24, s24, s37
    buffer_load_dwordx4 v152, s[4:7], s24 offen lds
    s_add_u32 s22, s22, s38
    s_lshl_b32 s40, s11, 3
    s_and_b32 s19, s10, 7
    s_add_u32 s40, s40, s19
    s_lshr_b32 s41, s10, 3
    s_mul_i32 s32, s41, 491520
    s_mul_i32 s19, s13, 24576
    s_add_u32 s32, s32, s19
    s_add_u32 s32, s32, 19406848
    s_mul_i32 s34, s13, 20480
    s_add_u32 s34, s34, 67072
    v_and_b32 v159, 31, v158
    v_lshrrev_b32 v160, 5, v158
    v_lshlrev_b32 v153, 4, v159
    v_lshl_add_u32 v153, v160, 15, v153
    s_mul_i32 s30, s13, 1572864
    s_lshl_b32 s19, s40, 9
    s_add_u32 s30, s30, s19
    s_add_u32 s30, s30, 7864320
    v_mov_b32 v0, 0
    v_mov_b32 v1, 0
    v_mov_b32 v2, 0
    v_mov_b32 v3, 0
    v_mov_b32 v4, 0
    v_mov_b32 v5, 0
    v_mov_b32 v6, 0
    v_mov_b32 v7, 0
    v_mov_b32 v8, 0
    v_mov_b32 v9, 0
    v_mov_b32 v10, 0
    v_mov_b32 v11, 0
    v_mov_b32 v12, 0
    v_mov_b32 v13, 0
    v_mov_b32 v14, 0
    v_mov_b32 v15, 0
    v_mov_b32 v16, 0
    v_mov_b32 v17, 0
    v_mov_b32 v18, 0
    v_mov_b32 v19, 0
    v_mov_b32 v20, 0
    v_mov_b32 v21, 0
    v_mov_b32 v22, 0
    v_mov_b32 v23, 0
    v_mov_b32 v24, 0
    v_mov_b32 v25, 0
    v_mov_b32 v26, 0
    v_mov_b32 v27, 0
    v_mov_b32 v28, 0
    v_mov_b32 v29, 0
    v_mov_b32 v30, 0
    v_mov_b32 v31, 0
    v_mov_b32 v32, 0
    v_mov_b32 v33, 0
    v_mov_b32 v34, 0
    v_mov_b32 v35, 0
    v_mov_b32 v36, 0
    v_mov_b32 v37, 0
    v_mov_b32 v38, 0
    v_mov_b32 v39, 0
    v_mov_b32 v40, 0
    v_mov_b32 v41, 0
    v_mov_b32 v42, 0
    v_mov_b32 v43, 0
    v_mov_b32 v44, 0
    v_mov_b32 v45, 0
    v_mov_b32 v46, 0
    v_mov_b32 v47, 0
    v_mov_b32 v48, 0
    v_mov_b32 v49, 0
    v_mov_b32 v50, 0
    v_mov_b32 v51, 0
    v_mov_b32 v52, 0
    v_mov_b32 v53, 0
    v_mov_b32 v54, 0
    v_mov_b32 v55, 0
    v_mov_b32 v56, 0
    v_mov_b32 v57, 0
    v_mov_b32 v58, 0
    v_mov_b32 v59, 0
    v_mov_b32 v60, 0
    v_mov_b32 v61, 0
    v_mov_b32 v62, 0
    v_mov_b32 v63, 0
    v_mov_b32 v64, 0
    v_mov_b32 v65, 0
    v_mov_b32 v66, 0
    v_mov_b32 v67, 0
    v_mov_b32 v68, 0
    v_mov_b32 v69, 0
    v_mov_b32 v70, 0
    v_mov_b32 v71, 0
    v_mov_b32 v72, 0
    v_mov_b32 v73, 0
    v_mov_b32 v74, 0
    v_mov_b32 v75, 0
    v_mov_b32 v76, 0
    v_mov_b32 v77, 0
    v_mov_b32 v78, 0
    v_mov_b32 v79, 0
    s_waitcnt vmcnt(0)
    s_barrier
    v_mov_b32 v80, -1
    v_mov_b32 v81, -1
    v_mov_b32 v82, -1
    v_mov_b32 v83, -1
    s_lshl_b32 s19, s10, 16
    s_lshl_b32 s24, s11, 12
    s_add_u32 s19, s19, s24
    s_lshl_b32 s24, s13, 10
    s_add_u32 s19, s19, s24
    s_add_u32 s19, s19, 14155776
    buffer_store_dwordx4 v[80:83], v152, s[4:7], s19 offen sc1
    s_add_u32 s19, s19, 32768
    buffer_store_dwordx4 v[80:83], v152, s[4:7], s19 offen sc1
    s_cmp_lt_u32 s13, 2
    s_cbranch_scc0 L_mark_done
    s_lshl_b32 s19, s10, 14
    s_lshl_b32 s24, s11, 11
    s_add_u32 s19, s19, s24
    s_lshl_b32 s24, s13, 10
    s_add_u32 s19, s19, s24
    s_add_u32 s19, s19, 16252928
    buffer_store_dwordx4 v[80:83], v152, s[4:7], s19 offen sc1
L_mark_done:
    s_add_u32 s23, s23, 20480
    s_mov_b32 s24, s22
    s_add_u32 m0, s23, 0
    s_nop 0
    buffer_load_dwordx4 v152, s[4:7], s24 offen lds
    s_add_u32 m0, s23, 1024
    s_add_u32 s24, s24, s37
    buffer_load_dwordx4 v152, s[4:7], s24 offen lds
    s_add_u32 m0, s23, 2048
    s_add_u32 s24, s24, s37
    buffer_load_dwordx4 v152, s[4:7], s24 offen lds
    s_add_u32 m0, s23, 3072
    s_add_u32 s24, s24, s37
    buffer_load_dwordx4 v152, s[4:7], s24 offen lds
    s_add_u32 m0, s23, 4096
    s_add_u32 s24, s24, s37
    buffer_load_dwordx4 v152, s[4:7], s24 offen lds
    s_add_u32 s22, s22, s38
    buffer_load_dwordx4 v[80:83], v152, s[4:7], s32 offen
    s_add_u32 s33, s32, 98304
    buffer_load_dwordx4 v[84:87], v152, s[4:7], s33 offen
    s_add_u32 s33, s32, 196608
    buffer_load_dwordx4 v[88:91], v152, s[4:7], s33 offen
    s_add_u32 s33, s32, 294912
    buffer_load_dwordx4 v[92:95], v152, s[4:7], s33 offen
    s_add_u32 s33, s32, 393216
    buffer_load_dwordx4 v[96:99], v152, s[4:7], s33 offen
    buffer_load_dwordx4 v[100:103], v153, s[4:7], s30 offen
    s_add_u32 s32, s32, 1024
    s_add_u32 s30, s30, 65536
    buffer_load_dwordx4 v[104:107], v152, s[4:7], s32 offen
    s_add_u32 s33, s32, 98304
    buffer_load_dwordx4 v[108:111], v152, s[4:7], s33 offen
    s_add_u32 s33, s32, 196608
    buffer_load_dwordx4 v[112:115], v152, s[4:7], s33 offen
    s_add_u32 s33, s32, 294912
    buffer_load_dwordx4 v[116:119], v152, s[4:7], s33 offen
    s_add_u32 s33, s32, 393216
    buffer_load_dwordx4 v[120:123], v152, s[4:7], s33 offen
    buffer_load_dwordx4 v[124:127], v153, s[4:7], s30 offen
    s_add_u32 s32, s32, 1024
    s_add_u32 s30, s30, 65536
    s_waitcnt vmcnt(12)
    s_barrier
    s_add_u32 s23, s23, 20480
    s_mov_b32 s24, s22
    s_add_u32 m0, s23, 0
    s_nop 0
    buffer_load_dwordx4 v152, s[4:7], s24 offen lds
    s_add_u32 m0, s23, 1024
    s_add_u32 s24, s24, s37
    buffer_load_dwordx4 v152, s[4:7], s24 offen lds
    s_add_u32 m0, s23, 2048
    s_add_u32 s24, s24, s37
    buffer_load_dwordx4 v152, s[4:7], s24 offen lds
    s_add_u32 m0, s23, 3072
    s_add_u32 s24, s24, s37
    buffer_load_dwordx4 v152, s[4:7], s24 offen lds
    s_add_u32 m0, s23, 4096
    s_add_u32 s24, s24, s37
    buffer_load_dwordx4 v152, s[4:7], s24 offen lds
    s_add_u32 s22, s22, s38
    buffer_load_dwordx4 v[128:131], v152, s[4:7], s32 offen
    s_add_u32 s33, s32, 98304
    buffer_load_dwordx4 v[132:135], v152, s[4:7], s33 offen
    s_add_u32 s33, s32, 196608
    buffer_load_dwordx4 v[136:139], v152, s[4:7], s33 offen
    s_add_u32 s33, s32, 294912
    buffer_load_dwordx4 v[140:143], v152, s[4:7], s33 offen
    s_add_u32 s33, s32, 393216
    buffer_load_dwordx4 v[144:147], v152, s[4:7], s33 offen
    buffer_load_dwordx4 v[148:151], v153, s[4:7], s30 offen
    s_add_u32 s32, s32, 1024
    s_add_u32 s30, s30, 65536
    s_waitcnt vmcnt(17)
    s_setprio 0
    v_mfma_f32_32x32x16_bf16 v[0:15], v[80:83], v[100:103], v[0:15]
    v_mfma_f32_32x32x16_bf16 v[16:31], v[84:87], v[100:103], v[16:31]
    v_mfma_f32_32x32x16_bf16 v[32:47], v[88:91], v[100:103], v[32:47]
    v_mfma_f32_32x32x16_bf16 v[48:63], v[92:95], v[100:103], v[48:63]
    v_mfma_f32_32x32x16_bf16 v[64:79], v[96:99], v[100:103], v[64:79]
    s_setprio 3
    buffer_load_dwordx4 v[80:83], v152, s[4:7], s32 offen
    s_add_u32 s33, s32, 98304
    buffer_load_dwordx4 v[84:87], v152, s[4:7], s33 offen
    s_add_u32 s33, s32, 196608
    buffer_load_dwordx4 v[88:91], v152, s[4:7], s33 offen
    s_add_u32 s33, s32, 294912
    buffer_load_dwordx4 v[92:95], v152, s[4:7], s33 offen
    s_add_u32 s33, s32, 393216
    buffer_load_dwordx4 v[96:99], v152, s[4:7], s33 offen
    buffer_load_dwordx4 v[100:103], v153, s[4:7], s30 offen
    s_add_u32 s32, s32, 1024
    s_add_u32 s30, s30, 65536
    s_waitcnt vmcnt(17)
    s_setprio 0
    v_mfma_f32_32x32x16_bf16 v[0:15], v[104:107], v[124:127], v[0:15]
    v_mfma_f32_32x32x16_bf16 v[16:31], v[108:111], v[124:127], v[16:31]
    v_mfma_f32_32x32x16_bf16 v[32:47], v[112:115], v[124:127], v[32:47]
    v_mfma_f32_32x32x16_bf16 v[48:63], v[116:119], v[124:127], v[48:63]
    v_mfma_f32_32x32x16_bf16 v[64:79], v[120:123], v[124:127], v[64:79]
    s_setprio 3
    buffer_load_dwordx4 v[104:107], v152, s[4:7], s32 offen
    s_add_u32 s33, s32, 98304
    buffer_load_dwordx4 v[108:111], v152, s[4:7], s33 offen
    s_add_u32 s33, s32, 196608
    buffer_load_dwordx4 v[112:115], v152, s[4:7], s33 offen
    s_add_u32 s33, s32, 294912
    buffer_load_dwordx4 v[116:119], v152, s[4:7], s33 offen
    s_add_u32 s33, s32, 393216
    buffer_load_dwordx4 v[120:123], v152, s[4:7], s33 offen
    buffer_load_dwordx4 v[124:127], v153, s[4:7], s30 offen
    s_add_u32 s32, s32, 1024
    s_add_u32 s30, s30, 65536
    s_waitcnt vmcnt(12)
    s_setprio 0
    v_mfma_f32_32x32x16_bf16 v[0:15], v[128:131], v[148:151], v[0:15]
    v_mfma_f32_32x32x16_bf16 v[16:31], v[132:135], v[148:151], v[16:31]
    v_mfma_f32_32x32x16_bf16 v[32:47], v[136:139], v[148:151], v[32:47]
    v_mfma_f32_32x32x16_bf16 v[48:63], v[140:143], v[148:151], v[48:63]
    v_mfma_f32_32x32x16_bf16 v[64:79], v[144:147], v[148:151], v[64:79]
    s_setprio 3
    s_barrier
    s_cmp_eq_u32 s8, 8
    s_cbranch_scc0 L_p_nosig
    s_lshl_b32 s19, s11, 5
    v_mov_b32 v154, s19
    v_mov_b32 v155, 1
    s_mov_b64 exec, 1
    global_atomic_add v154, v155, s[52:53] sc1
    s_mov_b64 exec, -1
L_p_nosig:
    s_sub_u32 s23, s23, 40960
    s_mov_b32 s24, s22
    s_add_u32 m0, s23, 0
    s_nop 0
    buffer_load_dwordx4 v152, s[4:7], s24 offen lds
    s_add_u32 m0, s23, 1024
    s_add_u32 s24, s24, s37
    buffer_load_dwordx4 v152, s[4:7], s24 offen lds
    s_add_u32 m0, s23, 2048
    s_add_u32 s24, s24, s37
    buffer_load_dwordx4 v152, s[4:7], s24 offen lds
    s_add_u32 m0, s23, 3072
    s_add_u32 s24, s24, s37
    buffer_load_dwordx4 v152, s[4:7], s24 offen lds
    s_add_u32 m0, s23, 4096
    s_add_u32 s24, s24, s37
    buffer_load_dwordx4 v152, s[4:7], s24 offen lds
    s_add_u32 s22, s22, s38
    buffer_load_dwordx4 v[128:131], v152, s[4:7], s32 offen
    s_add_u32 s33, s32, 98304
    buffer_load_dwordx4 v[132:135], v152, s[4:7], s33 offen
    s_add_u32 s33, s32, 196608
    buffer_load_dwordx4 v[136:139], v152, s[4:7], s33 offen
    s_add_u32 s33, s32, 294912
    buffer_load_dwordx4 v[140:143], v152, s[4:7], s33 offen
    s_add_u32 s33, s32, 393216
    buffer_load_dwordx4 v[144:147], v152, s[4:7], s33 offen
    buffer_load_dwordx4 v[148:151], v153, s[4:7], s30 offen
    s_add_u32 s32, s32, 1024
    s_add_u32 s30, s30, 65536
    s_waitcnt vmcnt(17)
    s_setprio 0
    v_mfma_f32_32x32x16_bf16 v[0:15], v[80:83], v[100:103], v[0:15]
    v_mfma_f32_32x32x16_bf16 v[16:31], v[84:87], v[100:103], v[16:31]
    v_mfma_f32_32x32x16_bf16 v[32:47], v[88:91], v[100:103], v[32:47]
    v_mfma_f32_32x32x16_bf16 v[48:63], v[92:95], v[100:103], v[48:63]
    v_mfma_f32_32x32x16_bf16 v[64:79], v[96:99], v[100:103], v[64:79]
    s_setprio 3
    buffer_load_dwordx4 v[80:83], v152, s[4:7], s32 offen
    s_add_u32 s33, s32, 98304
    buffer_load_dwordx4 v[84:87], v152, s[4:7], s33 offen
    s_add_u32 s33, s32, 196608
    buffer_load_dwordx4 v[88:91], v152, s[4:7], s33 offen
    s_add_u32 s33, s32, 294912
    buffer_load_dwordx4 v[92:95], v152, s[4:7], s33 offen
    s_add_u32 s33, s32, 393216
    buffer_load_dwordx4 v[96:99], v152, s[4:7], s33 offen
    buffer_load_dwordx4 v[100:103], v153, s[4:7], s30 offen
    s_add_u32 s32, s32, 1024
    s_add_u32 s30, s30, 65536
    s_waitcnt vmcnt(17)
    s_setprio 0
    v_mfma_f32_32x32x16_bf16 v[0:15], v[104:107], v[124:127], v[0:15]
    v_mfma_f32_32x32x16_bf16 v[16:31], v[108:111], v[124:127], v[16:31]
    v_mfma_f32_32x32x16_bf16 v[32:47], v[112:115], v[124:127], v[32:47]
    v_mfma_f32_32x32x16_bf16 v[48:63], v[116:119], v[124:127], v[48:63]
    v_mfma_f32_32x32x16_bf16 v[64:79], v[120:123], v[124:127], v[64:79]
    s_setprio 3
    buffer_load_dwordx4 v[104:107], v152, s[4:7], s32 offen
    s_add_u32 s33, s32, 98304
    buffer_load_dwordx4 v[108:111], v152, s[4:7], s33 offen
    s_add_u32 s33, s32, 196608
    buffer_load_dwordx4 v[112:115], v152, s[4:7], s33 offen
    s_add_u32 s33, s32, 294912
    buffer_load_dwordx4 v[116:119], v152, s[4:7], s33 offen
    s_add_u32 s33, s32, 393216
    buffer_load_dwordx4 v[120:123], v152, s[4:7], s33 offen
    buffer_load_dwordx4 v[124:127], v153, s[4:7], s30 offen
    s_add_u32 s32, s32, 1024
    s_add_u32 s30, s30, 65536
    s_waitcnt vmcnt(12)
    s_setprio 0
    v_mfma_f32_32x32x16_bf16 v[0:15], v[128:131], v[148:151], v[0:15]
    v_mfma_f32_32x32x16_bf16 v[16:31], v[132:135], v[148:151], v[16:31]
    v_mfma_f32_32x32x16_bf16 v[32:47], v[136:139], v[148:151], v[32:47]
    v_mfma_f32_32x32x16_bf16 v[48:63], v[140:143], v[148:151], v[48:63]
    v_mfma_f32_32x32x16_bf16 v[64:79], v[144:147], v[148:151], v[64:79]
    s_setprio 3
    s_barrier
    s_cmp_eq_u32 s8, 10
    s_cbranch_scc0 L_p_nowpf
    s_lshr_b32 s19, s2, 3
    s_mul_i32 s19, s19, 6400
    s_mul_i32 s24, s41, 204800
    s_add_u32 s19, s19, s24
    s_add_u32 s19, s19, 21372928
    v_min_u32 v154, 49, v158
    v_lshlrev_b32 v154, 7, v154
    buffer_load_dword v157, v154, s[4:7], s19 offen
L_p_nowpf:
    s_add_u32 s23, s23, 20480
    s_mov_b32 s24, s22
    s_add_u32 m0, s23, 0
    s_nop 0
    buffer_load_dwordx4 v152, s[4:7], s24 offen lds
    s_add_u32 m0, s23, 1024
    s_add_u32 s24, s24, s37
    buffer_load_dwordx4 v152, s[4:7], s24 offen lds
    s_add_u32 m0, s23, 2048
    s_add_u32 s24, s24, s37
    buffer_load_dwordx4 v152, s[4:7], s24 offen lds
    s_add_u32 m0, s23, 3072
    s_add_u32 s24, s24, s37
    buffer_load_dwordx4 v152, s[4:7], s24 offen lds
    s_add_u32 m0, s23, 4096
    s_add_u32 s24, s24, s37
    buffer_load_dwordx4 v152, s[4:7], s24 offen lds
    s_add_u32 s22, s22, s38
    buffer_load_dwordx4 v[128:131], v152, s[4:7], s32 offen
    s_add_u32 s33, s32, 98304
    buffer_load_dwordx4 v[132:135], v152, s[4:7], s33 offen
    s_add_u32 s33, s32, 196608
    buffer_load_dwordx4 v[136:139], v152, s[4:7], s33 offen
    s_add_u32 s33, s32, 294912
    buffer_load_dwordx4 v[140:143], v152, s[4:7], s33 offen
    s_add_u32 s33, s32, 393216
    buffer_load_dwordx4 v[144:147], v152, s[4:7], s33 offen
    buffer_load_dwordx4 v[148:151], v153, s[4:7], s30 offen
    s_add_u32 s32, s32, 1024
    s_add_u32 s30, s30, 65536
    s_waitcnt vmcnt(17)
    s_setprio 0
    v_mfma_f32_32x32x16_bf16 v[0:15], v[80:83], v[100:103], v[0:15]
    v_mfma_f32_32x32x16_bf16 v[16:31], v[84:87], v[100:103], v[16:31]
    v_mfma_f32_32x32x16_bf16 v[32:47], v[88:91], v[100:103], v[32:47]
    v_mfma_f32_32x32x16_bf16 v[48:63], v[92:95], v[100:103], v[48:63]
    v_mfma_f32_32x32x16_bf16 v[64:79], v[96:99], v[100:103], v[64:79]
    s_setprio 3
    buffer_load_dwordx4 v[80:83], v152, s[4:7], s32 offen
    s_add_u32 s33, s32, 98304
    buffer_load_dwordx4 v[84:87], v152, s[4:7], s33 offen
    s_add_u32 s33, s32, 196608
    buffer_load_dwordx4 v[88:91], v152, s[4:7], s33 offen
    s_add_u32 s33, s32, 294912
    buffer_load_dwordx4 v[92:95], v152, s[4:7], s33 offen
    s_add_u32 s33, s32, 393216
    buffer_load_dwordx4 v[96:99], v152, s[4:7], s33 offen
    buffer_load_dwordx4 v[100:103], v153, s[4:7], s30 offen
    s_add_u32 s32, s32, 1024
    s_add_u32 s30, s30, 65536
    s_waitcnt vmcnt(17)
    s_setprio 0
    v_mfma_f32_32x32x16_bf16 v[0:15], v[104:107], v[124:127], v[0:15]
    v_mfma_f32_32x32x16_bf16 v[16:31], v[108:111], v[124:127], v[16:31]
    v_mfma_f32_32x32x16_bf16 v[32:47], v[112:115], v[124:127], v[32:47]
    v_mfma_f32_32x32x16_bf16 v[48:63], v[116:119], v[124:127], v[48:63]
    v_mfma_f32_32x32x16_bf16 v[64:79], v[120:123], v[124:127], v[64:79]
    s_setprio 3
    buffer_load_dwordx4 v[104:107], v152, s[4:7], s32 offen
    s_add_u32 s33, s32, 98304
    buffer_load_dwordx4 v[108:111], v152, s[4:7], s33 offen
    s_add_u32 s33, s32, 196608
    buffer_load_dwordx4 v[112:115], v152, s[4:7], s33 offen
    s_add_u32 s33, s32, 294912
    buffer_load_dwordx4 v[116:119], v152, s[4:7], s33 offen
    s_add_u32 s33, s32, 393216
    buffer_load_dwordx4 v[120:123], v152, s[4:7], s33 offen
    buffer_load_dwordx4 v[124:127], v153, s[4:7], s30 offen
    s_add_u32 s32, s32, 1024
    s_add_u32 s30, s30, 65536
    s_waitcnt vmcnt(12)
    s_setprio 0
    v_mfma_f32_32x32x16_bf16 v[0:15], v[128:131], v[148:151], v[0:15]
    v_mfma_f32_32x32x16_bf16 v[16:31], v[132:135], v[148:151], v[16:31]
    v_mfma_f32_32x32x16_bf16 v[32:47], v[136:139], v[148:151], v[32:47]
    v_mfma_f32_32x32x16_bf16 v[48:63], v[140:143], v[148:151], v[48:63]
    v_mfma_f32_32x32x16_bf16 v[64:79], v[144:147], v[148:151], v[64:79]
    s_setprio 3
    buffer_load_dwordx4 v[128:131], v152, s[4:7], s32 offen
    s_add_u32 s33, s32, 98304
    buffer_load_dwordx4 v[132:135], v152, s[4:7], s33 offen
    s_add_u32 s33, s32, 196608
    buffer_load_dwordx4 v[136:139], v152, s[4:7], s33 offen
    s_add_u32 s33, s32, 294912
    buffer_load_dwordx4 v[140:143], v152, s[4:7], s33 offen
    s_add_u32 s33, s32, 393216
    buffer_load_dwordx4 v[144:147], v152, s[4:7], s33 offen
    buffer_load_dwordx4 v[148:151], v153, s[4:7], s30 offen
    s_add_u32 s32, s32, 1024
    s_add_u32 s30, s30, 65536
    s_waitcnt vmcnt(12)
    s_setprio 0
    v_mfma_f32_32x32x16_bf16 v[0:15], v[80:83], v[100:103], v[0:15]
    v_mfma_f32_32x32x16_bf16 v[16:31], v[84:87], v[100:103], v[16:31]
    v_mfma_f32_32x32x16_bf16 v[32:47], v[88:91], v[100:103], v[32:47]
    v_mfma_f32_32x32x16_bf16 v[48:63], v[92:95], v[100:103], v[48:63]
    v_mfma_f32_32x32x16_bf16 v[64:79], v[96:99], v[100:103], v[64:79]
    s_setprio 3
    s_barrier
    s_add_u32 s23, s23, 20480
    s_mov_b32 s24, s22
    s_add_u32 m0, s23, 0
    s_nop 0
    buffer_load_dwordx4 v152, s[4:7], s24 offen lds
    s_add_u32 m0, s23, 1024
    s_add_u32 s24, s24, s37
    buffer_load_dwordx4 v152, s[4:7], s24 offen lds
    s_add_u32 m0, s23, 2048
    s_add_u32 s24, s24, s37
    buffer_load_dwordx4 v152, s[4:7], s24 offen lds
    s_add_u32 m0, s23, 3072
    s_add_u32 s24, s24, s37
    buffer_load_dwordx4 v152, s[4:7], s24 offen lds
    s_add_u32 m0, s23, 4096
    s_add_u32 s24, s24, s37
    buffer_load_dwordx4 v152, s[4:7], s24 offen lds
    s_add_u32 s22, s22, s38
    buffer_load_dwordx4 v[80:83], v152, s[4:7], s32 offen
    s_add_u32 s33, s32, 98304
    buffer_load_dwordx4 v[84:87], v152, s[4:7], s33 offen
    s_add_u32 s33, s32, 196608
    buffer_load_dwordx4 v[88:91], v152, s[4:7], s33 offen
    s_add_u32 s33, s32, 294912
    buffer_load_dwordx4 v[92:95], v152, s[4:7], s33 offen
    s_add_u32 s33, s32, 393216
    buffer_load_dwordx4 v[96:99], v152, s[4:7], s33 offen
    buffer_load_dwordx4 v[100:103], v153, s[4:7], s30 offen
    s_add_u32 s32, s32, 1024
    s_add_u32 s30, s30, 65536
    s_waitcnt vmcnt(17)
    s_setprio 0
    v_mfma_f32_32x32x16_bf16 v[0:15], v[104:107], v[124:127], v[0:15]
    v_mfma_f32_32x32x16_bf16 v[16:31], v[108:111], v[124:127], v[16:31]
    v_mfma_f32_32x32x16_bf16 v[32:47], v[112:115], v[124:127], v[32:47]
    v_mfma_f32_32x32x16_bf16 v[48:63], v[116:119], v[124:127], v[48:63]
    v_mfma_f32_32x32x16_bf16 v[64:79], v[120:123], v[124:127], v[64:79]
    s_setprio 3
    buffer_load_dwordx4 v[104:107], v152, s[4:7], s32 offen
    s_add_u32 s33, s32, 98304
    buffer_load_dwordx4 v[108:111], v152, s[4:7], s33 offen
    s_add_u32 s33, s32, 196608
    buffer_load_dwordx4 v[112:115], v152, s[4:7], s33 offen
    s_add_u32 s33, s32, 294912
    buffer_load_dwordx4 v[116:119], v152, s[4:7], s33 offen
    s_add_u32 s33, s32, 393216
    buffer_load_dwordx4 v[120:123], v152, s[4:7], s33 offen
    buffer_load_dwordx4 v[124:127], v153, s[4:7], s30 offen
    s_add_u32 s32, s32, 1024
    s_add_u32 s30, s30, 65536
    s_waitcnt vmcnt(17)
    s_setprio 0
    v_mfma_f32_32x32x16_bf16 v[0:15], v[128:131], v[148:151], v[0:15]
    v_mfma_f32_32x32x16_bf16 v[16:31], v[132:135], v[148:151], v[16:31]
    v_mfma_f32_32x32x16_bf16 v[32:47], v[136:139], v[148:151], v[32:47]
    v_mfma_f32_32x32x16_bf16 v[48:63], v[140:143], v[148:151], v[48:63]
    v_mfma_f32_32x32x16_bf16 v[64:79], v[144:147], v[148:151], v[64:79]
    s_setprio 3
    buffer_load_dwordx4 v[128:131], v152, s[4:7], s32 offen
    s_add_u32 s33, s32, 98304
    buffer_load_dwordx4 v[132:135], v152, s[4:7], s33 offen
    s_add_u32 s33, s32, 196608
    buffer_load_dwordx4 v[136:139], v152, s[4:7], s33 offen
    s_add_u32 s33, s32, 294912
    buffer_load_dwordx4 v[140:143], v152, s[4:7], s33 offen
    s_add_u32 s33, s32, 393216
    buffer_load_dwordx4 v[144:147], v152, s[4:7], s33 offen
    buffer_load_dwordx4 v[148:151], v153, s[4:7], s30 offen
    s_add_u32 s32, s32, 1024
    s_add_u32 s30, s30, 65536
    s_waitcnt vmcnt(12)
    s_setprio 0
    v_mfma_f32_32x32x16_bf16 v[0:15], v[80:83], v[100:103], v[0:15]
    v_mfma_f32_32x32x16_bf16 v[16:31], v[84:87], v[100:103], v[16:31]
    v_mfma_f32_32x32x16_bf16 v[32:47], v[88:91], v[100:103], v[32:47]
    v_mfma_f32_32x32x16_bf16 v[48:63], v[92:95], v[100:103], v[48:63]
    v_mfma_f32_32x32x16_bf16 v[64:79], v[96:99], v[100:103], v[64:79]
    s_setprio 3
    s_barrier
    s_cmp_eq_u32 s8, 11
    s_cbranch_scc0 L_p_nochk
    s_lshl_b32 s19, s11, 5
    v_mov_b32 v154, s19
    s_mov_b32 s36, 400000
L_p_chk:
    global_load_dword v155, v154, s[52:53] sc1
    s_waitcnt vmcnt(0)
    v_readfirstlane_b32 s19, v155
    s_cmp_ge_u32 s19, 32
    s_cbranch_scc1 L_p_nochk
    s_sub_u32 s36, s36, 1
    s_cmp_eq_u32 s36, 0
    s_cbranch_scc1 L_p_nochk
    s_sleep 2
    s_branch L_p_chk
L_p_nochk:
    s_sub_u32 s23, s23, 40960
    s_mov_b32 s24, s22
    s_add_u32 m0, s23, 0
    s_nop 0
    buffer_load_dwordx4 v152, s[4:7], s24 offen lds
    s_add_u32 m0, s23, 1024
    s_add_u32 s24, s24, s37
    buffer_load_dwordx4 v152, s[4:7], s24 offen lds
    s_add_u32 m0, s23, 2048
    s_add_u32 s24, s24, s37
    buffer_load_dwordx4 v152, s[4:7], s24 offen lds
    s_add_u32 m0, s23, 3072
    s_add_u32 s24, s24, s37
    buffer_load_dwordx4 v152, s[4:7], s24 offen lds
    s_add_u32 m0, s23, 4096
    s_add_u32 s24, s24, s37
    buffer_load_dwordx4 v152, s[4:7], s24 offen lds
    s_add_u32 s22, s22, s38
    buffer_load_dwordx4 v[80:83], v152, s[4:7], s32 offen
    s_add_u32 s33, s32, 98304
    buffer_load_dwordx4 v[84:87], v152, s[4:7], s33 offen
    s_add_u32 s33, s32, 196608
    buffer_load_dwordx4 v[88:91], v152, s[4:7], s33 offen
    s_add_u32 s33, s32, 294912
    buffer_load_dwordx4 v[92:95], v152, s[4:7], s33 offen
    s_add_u32 s33, s32, 393216
    buffer_load_dwordx4 v[96:99], v152, s[4:7], s33 offen
    buffer_load_dwordx4 v[100:103], v153, s[4:7], s30 offen
    s_add_u32 s32, s32, 1024
    s_add_u32 s30, s30, 65536
    s_waitcnt vmcnt(17)
    s_setprio 0
    v_mfma_f32_32x32x16_bf16 v[0:15], v[104:107], v[124:127], v[0:15]
    v_mfma_f32_32x32x16_bf16 v[16:31], v[108:111], v[124:127], v[16:31]
    v_mfma_f32_32x32x16_bf16 v[32:47], v[112:115], v[124:127], v[32:47]
    v_mfma_f32_32x32x16_bf16 v[48:63], v[116:119], v[124:127], v[48:63]
    v_mfma_f32_32x32x16_bf16 v[64:79], v[120:123], v[124:127], v[64:79]
    s_setprio 3
    buffer_load_dwordx4 v[104:107], v152, s[4:7], s32 offen
    s_add_u32 s33, s32, 98304
    buffer_load_dwordx4 v[108:111], v152, s[4:7], s33 offen
    s_add_u32 s33, s32, 196608
    buffer_load_dwordx4 v[112:115], v152, s[4:7], s33 offen
    s_add_u32 s33, s32, 294912
    buffer_load_dwordx4 v[116:119], v152, s[4:7], s33 offen
    s_add_u32 s33, s32, 393216
    buffer_load_dwordx4 v[120:123], v152, s[4:7], s33 offen
    buffer_load_dwordx4 v[124:127], v153, s[4:7], s30 offen
    s_add_u32 s32, s32, 1024
    s_add_u32 s30, s30, 65536
    s_waitcnt vmcnt(17)
    s_setprio 0
    v_mfma_f32_32x32x16_bf16 v[0:15], v[128:131], v[148:151], v[0:15]
    v_mfma_f32_32x32x16_bf16 v[16:31], v[132:135], v[148:151], v[16:31]
    v_mfma_f32_32x32x16_bf16 v[32:47], v[136:139], v[148:151], v[32:47]
    v_mfma_f32_32x32x16_bf16 v[48:63], v[140:143], v[148:151], v[48:63]
    v_mfma_f32_32x32x16_bf16 v[64:79], v[144:147], v[148:151], v[64:79]
    s_setprio 3
    buffer_load_dwordx4 v[128:131], v152, s[4:7], s32 offen
    s_add_u32 s33, s32, 98304
    buffer_load_dwordx4 v[132:135], v152, s[4:7], s33 offen
    s_add_u32 s33, s32, 196608
    buffer_load_dwordx4 v[136:139], v152, s[4:7], s33 offen
    s_add_u32 s33, s32, 294912
    buffer_load_dwordx4 v[140:143], v152, s[4:7], s33 offen
    s_add_u32 s33, s32, 393216
    buffer_load_dwordx4 v[144:147], v152, s[4:7], s33 offen
    buffer_load_dwordx4 v[148:151], v153, s[4:7], s30 offen
    s_add_u32 s32, s32, 1024
    s_add_u32 s30, s30, 65536
    s_waitcnt vmcnt(12)
    s_setprio 0
    v_mfma_f32_32x32x16_bf16 v[0:15], v[80:83], v[100:103], v[0:15]
    v_mfma_f32_32x32x16_bf16 v[16:31], v[84:87], v[100:103], v[16:31]
    v_mfma_f32_32x32x16_bf16 v[32:47], v[88:91], v[100:103], v[32:47]
    v_mfma_f32_32x32x16_bf16 v[48:63], v[92:95], v[100:103], v[48:63]
    v_mfma_f32_32x32x16_bf16 v[64:79], v[96:99], v[100:103], v[64:79]
    s_setprio 3
    buffer_load_dwordx4 v[80:83], v152, s[4:7], s32 offen
    s_add_u32 s33, s32, 98304
    buffer_load_dwordx4 v[84:87], v152, s[4:7], s33 offen
    s_add_u32 s33, s32, 196608
    buffer_load_dwordx4 v[88:91], v152, s[4:7], s33 offen
    s_add_u32 s33, s32, 294912
    buffer_load_dwordx4 v[92:95], v152, s[4:7], s33 offen
    s_add_u32 s33, s32, 393216
    buffer_load_dwordx4 v[96:99], v152, s[4:7], s33 offen
    buffer_load_dwordx4 v[100:103], v153, s[4:7], s30 offen
    s_add_u32 s32, s32, 1024
    s_add_u32 s30, s30, 65536
    s_waitcnt vmcnt(12)
    s_setprio 0
    v_mfma_f32_32x32x16_bf16 v[0:15], v[104:107], v[124:127], v[0:15]
    v_mfma_f32_32x32x16_bf16 v[16:31], v[108:111], v[124:127], v[16:31]
    v_mfma_f32_32x32x16_bf16 v[32:47], v[112:115], v[124:127], v[32:47]
    v_mfma_f32_32x32x16_bf16 v[48:63], v[116:119], v[124:127], v[48:63]
    v_mfma_f32_32x32x16_bf16 v[64:79], v[120:123], v[124:127], v[64:79]
    s_setprio 3
    s_barrier
    s_add_u32 s23, s23, 20480
    s_mov_b32 s24, s22
    s_add_u32 m0, s23, 0
    s_nop 0
    buffer_load_dwordx4 v152, s[4:7], s24 offen lds
    s_add_u32 m0, s23, 1024
    s_add_u32 s24, s24, s37
    buffer_load_dwordx4 v152, s[4:7], s24 offen lds
    s_add_u32 m0, s23, 2048
    s_add_u32 s24, s24, s37
    buffer_load_dwordx4 v152, s[4:7], s24 offen lds
    s_add_u32 m0, s23, 3072
    s_add_u32 s24, s24, s37
    buffer_load_dwordx4 v152, s[4:7], s24 offen lds
    s_add_u32 m0, s23, 4096
    s_add_u32 s24, s24, s37
    buffer_load_dwordx4 v152, s[4:7], s24 offen lds
    s_add_u32 s22, s22, s38
    buffer_load_dwordx4 v[104:107], v152, s[4:7], s32 offen
    s_add_u32 s33, s32, 98304
    buffer_load_dwordx4 v[108:111], v152, s[4:7], s33 offen
    s_add_u32 s33, s32, 196608
    buffer_load_dwordx4 v[112:115], v152, s[4:7], s33 offen
    s_add_u32 s33, s32, 294912
    buffer_load_dwordx4 v[116:119], v152, s[4:7], s33 offen
    s_add_u32 s33, s32, 393216
    buffer_load_dwordx4 v[120:123], v152, s[4:7], s33 offen
    buffer_load_dwordx4 v[124:127], v153, s[4:7], s30 offen
    s_add_u32 s32, s32, 1024
    s_add_u32 s30, s30, 65536
    s_waitcnt vmcnt(17)
    s_setprio 0
    v_mfma_f32_32x32x16_bf16 v[0:15], v[128:131], v[148:151], v[0:15]
    v_mfma_f32_32x32x16_bf16 v[16:31], v[132:135], v[148:151], v[16:31]
    v_mfma_f32_32x32x16_bf16 v[32:47], v[136:139], v[148:151], v[32:47]
    v_mfma_f32_32x32x16_bf16 v[48:63], v[140:143], v[148:151], v[48:63]
    v_mfma_f32_32x32x16_bf16 v[64:79], v[144:147], v[148:151], v[64:79]
    s_setprio 3
    buffer_load_dwordx4 v[128:131], v152, s[4:7], s32 offen
    s_add_u32 s33, s32, 98304
    buffer_load_dwordx4 v[132:135], v152, s[4:7], s33 offen
    s_add_u32 s33, s32, 196608
    buffer_load_dwordx4 v[136:139], v152, s[4:7], s33 offen
    s_add_u32 s33, s32, 294912
    buffer_load_dwordx4 v[140:143], v152, s[4:7], s33 offen
    s_add_u32 s33, s32, 393216
    buffer_load_dwordx4 v[144:147], v152, s[4:7], s33 offen
    buffer_load_dwordx4 v[148:151], v153, s[4:7], s30 offen
    s_add_u32 s32, s32, 1024
    s_add_u32 s30, s30, 65536
    s_waitcnt vmcnt(17)
    s_setprio 0
    v_mfma_f32_32x32x16_bf16 v[0:15], v[80:83], v[100:103], v[0:15]
    v_mfma_f32_32x32x16_bf16 v[16:31], v[84:87], v[100:103], v[16:31]
    v_mfma_f32_32x32x16_bf16 v[32:47], v[88:91], v[100:103], v[32:47]
    v_mfma_f32_32x32x16_bf16 v[48:63], v[92:95], v[100:103], v[48:63]
    v_mfma_f32_32x32x16_bf16 v[64:79], v[96:99], v[100:103], v[64:79]
    s_setprio 3
    buffer_load_dwordx4 v[80:83], v152, s[4:7], s32 offen
    s_add_u32 s33, s32, 98304
    buffer_load_dwordx4 v[84:87], v152, s[4:7], s33 offen
    s_add_u32 s33, s32, 196608
    buffer_load_dwordx4 v[88:91], v152, s[4:7], s33 offen
    s_add_u32 s33, s32, 294912
    buffer_load_dwordx4 v[92:95], v152, s[4:7], s33 offen
    s_add_u32 s33, s32, 393216
    buffer_load_dwordx4 v[96:99], v152, s[4:7], s33 offen
    buffer_load_dwordx4 v[100:103], v153, s[4:7], s30 offen
    s_add_u32 s32, s32, 1024
    s_add_u32 s30, s30, 65536
    s_waitcnt vmcnt(12)
    s_setprio 0
    v_mfma_f32_32x32x16_bf16 v[0:15], v[104:107], v[124:127], v[0:15]
    v_mfma_f32_32x32x16_bf16 v[16:31], v[108:111], v[124:127], v[16:31]
    v_mfma_f32_32x32x16_bf16 v[32:47], v[112:115], v[124:127], v[32:47]
    v_mfma_f32_32x32x16_bf16 v[48:63], v[116:119], v[124:127], v[48:63]
    v_mfma_f32_32x32x16_bf16 v[64:79], v[120:123], v[124:127], v[64:79]
    s_setprio 3
    s_barrier
    buffer_load_dwordx4 v[104:107], v152, s[4:7], s32 offen
    s_add_u32 s33, s32, 98304
    buffer_load_dwordx4 v[108:111], v152, s[4:7], s33 offen
    s_add_u32 s33, s32, 196608
    buffer_load_dwordx4 v[112:115], v152, s[4:7], s33 offen
    s_add_u32 s33, s32, 294912
    buffer_load_dwordx4 v[116:119], v152, s[4:7], s33 offen
    s_add_u32 s33, s32, 393216
    buffer_load_dwordx4 v[120:123], v152, s[4:7], s33 offen
    buffer_load_dwordx4 v[124:127], v153, s[4:7], s30 offen
    s_add_u32 s32, s32, 1024
    s_add_u32 s30, s30, 65536
    s_waitcnt vmcnt(12)
    s_setprio 0
    v_mfma_f32_32x32x16_bf16 v[0:15], v[128:131], v[148:151], v[0:15]
    v_mfma_f32_32x32x16_bf16 v[16:31], v[132:135], v[148:151], v[16:31]
    v_mfma_f32_32x32x16_bf16 v[32:47], v[136:139], v[148:151], v[32:47]
    v_mfma_f32_32x32x16_bf16 v[48:63], v[140:143], v[148:151], v[48:63]
    v_mfma_f32_32x32x16_bf16 v[64:79], v[144:147], v[148:151], v[64:79]
    s_setprio 3
    buffer_load_dwordx4 v[128:131], v152, s[4:7], s32 offen
    s_add_u32 s33, s32, 98304
    buffer_load_dwordx4 v[132:135], v152, s[4:7], s33 offen
    s_add_u32 s33, s32, 196608
    buffer_load_dwordx4 v[136:139], v152, s[4:7], s33 offen
    s_add_u32 s33, s32, 294912
    buffer_load_dwordx4 v[140:143], v152, s[4:7], s33 offen
    s_add_u32 s33, s32, 393216
    buffer_load_dwordx4 v[144:147], v152, s[4:7], s33 offen
    buffer_load_dwordx4 v[148:151], v153, s[4:7], s30 offen
    s_add_u32 s32, s32, 1024
    s_add_u32 s30, s30, 65536
    s_waitcnt vmcnt(12)
    s_setprio 0
    v_mfma_f32_32x32x16_bf16 v[0:15], v[80:83], v[100:103], v[0:15]
    v_mfma_f32_32x32x16_bf16 v[16:31], v[84:87], v[100:103], v[16:31]
    v_mfma_f32_32x32x16_bf16 v[32:47], v[88:91], v[100:103], v[32:47]
    v_mfma_f32_32x32x16_bf16 v[48:63], v[92:95], v[100:103], v[48:63]
    v_mfma_f32_32x32x16_bf16 v[64:79], v[96:99], v[100:103], v[64:79]
    s_setprio 3
    s_waitcnt vmcnt(6)
    s_setprio 0
    v_mfma_f32_32x32x16_bf16 v[0:15], v[104:107], v[124:127], v[0:15]
    v_mfma_f32_32x32x16_bf16 v[16:31], v[108:111], v[124:127], v[16:31]
    v_mfma_f32_32x32x16_bf16 v[32:47], v[112:115], v[124:127], v[32:47]
    v_mfma_f32_32x32x16_bf16 v[48:63], v[116:119], v[124:127], v[48:63]
    v_mfma_f32_32x32x16_bf16 v[64:79], v[120:123], v[124:127], v[64:79]
    s_setprio 3
    s_waitcnt vmcnt(0)
    s_setprio 0
    v_mfma_f32_32x32x16_bf16 v[0:15], v[128:131], v[148:151], v[0:15]
    v_mfma_f32_32x32x16_bf16 v[16:31], v[132:135], v[148:151], v[16:31]
    v_mfma_f32_32x32x16_bf16 v[32:47], v[136:139], v[148:151], v[32:47]
    v_mfma_f32_32x32x16_bf16 v[48:63], v[140:143], v[148:151], v[48:63]
    v_mfma_f32_32x32x16_bf16 v[64:79], v[144:147], v[148:151], v[64:79]
    s_setprio 3
    s_barrier
    s_barrier
    s_nop 7
    v_add_u32 v154, s34, v152
    ds_write_b128 v154, v[0:3] offset:0
    ds_write_b128 v154, v[4:7] offset:1024
    ds_write_b128 v154, v[8:11] offset:2048
    ds_write_b128 v154, v[12:15] offset:3072
    ds_write_b128 v154, v[16:19] offset:4096
    ds_write_b128 v154, v[20:23] offset:5120
    ds_write_b128 v154, v[24:27] offset:6144
    ds_write_b128 v154, v[28:31] offset:7168
    ds_write_b128 v154, v[32:35] offset:8192
    ds_write_b128 v154, v[36:39] offset:9216
    ds_write_b128 v154, v[40:43] offset:10240
    ds_write_b128 v154, v[44:47] offset:11264
    ds_write_b128 v154, v[48:51] offset:12288
    ds_write_b128 v154, v[52:55] offset:13312
    ds_write_b128 v154, v[56:59] offset:14336
    ds_write_b128 v154, v[60:63] offset:15360
    ds_write_b128 v154, v[64:67] offset:16384
    ds_write_b128 v154, v[68:71] offset:17408
    ds_write_b128 v154, v[72:75] offset:18432
    ds_write_b128 v154, v[76:79] offset:19456
    s_lshl_b32 s19, s40, 7
    s_add_u32 s19, s19, 16777216
    v_lshlrev_b32 v155, 2, v159
    buffer_load_dword v150, v155, s[4:7], s19 offen
    s_waitcnt lgkmcnt(0)
    s_lshl_b32 s40, s11, 3
    s_and_b32 s19, s10, 7
    s_add_u32 s40, s40, s19
    s_lshr_b32 s41, s10, 3
    v_mbcnt_lo_u32_b32 v112, -1, 0
    v_mbcnt_hi_u32_b32 v112, -1, v112
    s_barrier
    s_mul_i32 s42, s13, 10
    s_mov_b32 s43, 4
    s_mul_i32 s19, s41, 5
    s_add_u32 s19, s19, s43
    s_mul_i32 s19, s19, 40
    s_add_u32 s19, s19, s42
    s_lshl_b32 s19, s19, 10
    s_add_u32 s44, s19, 21372928
    v_lshlrev_b32 v113, 4, v112
    s_lshl_b32 s19, s13, 12
    v_add_u32 v154, 67072, v152
    v_add_u32 v155, s19, v154
    s_lshl_b32 s19, s13, 10
    s_add_u32 s19, s19, 16384
    v_add_u32 v156, s19, v154
    ds_read_b128 v[80:83], v155 offset:0
    ds_read_b128 v[84:87], v155 offset:1024
    ds_read_b128 v[88:91], v155 offset:2048
    ds_read_b128 v[92:95], v155 offset:3072
    ds_read_b128 v[116:119], v156 offset:0
    ds_read_b128 v[96:99], v155 offset:20480
    ds_read_b128 v[100:103], v155 offset:21504
    ds_read_b128 v[104:107], v155 offset:22528
    ds_read_b128 v[108:111], v155 offset:23552
    ds_read_b128 v[120:123], v156 offset:20480
    s_waitcnt lgkmcnt(0)
    v_add_f32 v130, v80, v96
    v_add_f32 v131, v81, v97
    v_add_f32 v132, v82, v98
    v_add_f32 v133, v83, v99
    v_add_f32 v134, v84, v100
    v_add_f32 v135, v85, v101
    v_add_f32 v136, v86, v102
    v_add_f32 v137, v87, v103
    v_add_f32 v138, v88, v104
    v_add_f32 v139, v89, v105
    v_add_f32 v140, v90, v106
    v_add_f32 v141, v91, v107
    v_add_f32 v142, v92, v108
    v_add_f32 v143, v93, v109
    v_add_f32 v144, v94, v110
    v_add_f32 v145, v95, v111
    v_add_f32 v146, v116, v120
    v_add_f32 v147, v117, v121
    v_add_f32 v148, v118, v122
    v_add_f32 v149, v119, v123
    ds_read_b128 v[80:83], v155 offset:40960
    ds_read_b128 v[84:87], v155 offset:41984
    ds_read_b128 v[88:91], v155 offset:43008
    ds_read_b128 v[92:95], v155 offset:44032
    ds_read_b128 v[116:119], v156 offset:40960
    ds_read_b128 v[96:99], v155 offset:61440
    ds_read_b128 v[100:103], v155 offset:62464
    ds_read_b128 v[104:107], v155 offset:63488
    ds_read_b128 v[108:111], v155 offset:64512
    ds_read_b128 v[120:123], v156 offset:61440
    s_waitcnt lgkmcnt(0)
    v_add_f32 v80, v80, v96
    v_add_f32 v130, v130, v80
    v_add_f32 v81, v81, v97
    v_add_f32 v131, v131, v81
    v_add_f32 v82, v82, v98
    v_add_f32 v132, v132, v82
    v_add_f32 v83, v83, v99
    v_add_f32 v133, v133, v83
    v_add_f32 v84, v84, v100
    v_add_f32 v134, v134, v84
    v_add_f32 v85, v85, v101
    v_add_f32 v135, v135, v85
    v_add_f32 v86, v86, v102
    v_add_f32 v136, v136, v86
    v_add_f32 v87, v87, v103
    v_add_f32 v137, v137, v87
    v_add_f32 v88, v88, v104
    v_add_f32 v138, v138, v88
    v_add_f32 v89, v89, v105
    v_add_f32 v139, v139, v89
    v_add_f32 v90, v90, v106
    v_add_f32 v140, v140, v90
    v_add_f32 v91, v91, v107
    v_add_f32 v141, v141, v91
    v_add_f32 v92, v92, v108
    v_add_f32 v142, v142, v92
    v_add_f32 v93, v93, v109
    v_add_f32 v143, v143, v93
    v_add_f32 v94, v94, v110
    v_add_f32 v144, v144, v94
    v_add_f32 v95, v95, v111
    v_add_f32 v145, v145, v95
    v_add_f32 v116, v116, v120
    v_add_f32 v146, v146, v116
    v_add_f32 v117, v117, v121
    v_add_f32 v147, v147, v117
    v_add_f32 v118, v118, v122
    v_add_f32 v148, v148, v118
    v_add_f32 v119, v119, v123
    v_add_f32 v149, v149, v119
    v_lshrrev_b32 v114, 5, v112
    v_lshlrev_b32 v114, 15, v114
    v_and_b32 v115, 31, v112
    v_lshl_add_u32 v114, v115, 4, v114
    s_lshl_b32 s45, s8, 16
    s_lshl_b32 s19, s40, 9
    s_add_u32 s45, s45, s19
    s_add_u32 s45, s45, 14155776
    s_add_u32 s47, s8, -8
    s_lshl_b32 s47, s47, 16
    s_lshl_b32 s19, s40, 8
    s_add_u32 s47, s47, s19
    s_add_u32 s47, s47, 16252928
    s_lshl_b32 s37, s8, 10
    v_lshlrev_b32 v115, 4, v112
    v_add_u32 v115, s37, v115
    s_mov_b32 s46, 4096
    s_mov_b32 s36, s45
    s_add_u32 m0, s37, 0
    s_nop 0
    buffer_load_dwordx4 v114, s[4:7], s36 offen sc1 lds
    s_add_u32 s36, s36, 786432
    s_add_u32 m0, s37, 12288
    s_nop 0
    buffer_load_dwordx4 v114, s[4:7], s36 offen sc1 lds
    s_add_u32 s36, s36, 786432
    v_lshrrev_b32 v95, 4, v112
    v_lshlrev_b32 v95, 14, v95
    v_and_b32 v94, 15, v112
    v_lshl_add_u32 v95, v94, 4, v95
    s_add_u32 m0, s37, 24576
    s_nop 0
    buffer_load_dwordx4 v95, s[4:7], s47 offen sc1 lds
L_odma_donepa:
    buffer_load_dwordx4 v[0:3], v113, s[4:7], s44 offen offset:0
    buffer_load_dwordx4 v[4:7], v113, s[4:7], s44 offen offset:1024
    buffer_load_dwordx4 v[8:11], v113, s[4:7], s44 offen offset:2048
    buffer_load_dwordx4 v[12:15], v113, s[4:7], s44 offen offset:3072
    s_add_u32 s44, s44, 4096
    buffer_load_dwordx4 v[16:19], v113, s[4:7], s44 offen offset:0
    buffer_load_dwordx4 v[20:23], v113, s[4:7], s44 offen offset:1024
    buffer_load_dwordx4 v[24:27], v113, s[4:7], s44 offen offset:2048
    buffer_load_dwordx4 v[28:31], v113, s[4:7], s44 offen offset:3072
    s_waitcnt vmcnt(8)
    s_branch L_ochkp
L_oretryp:
    s_mov_b32 s36, s45
    s_add_u32 m0, s37, 0
    s_nop 0
    buffer_load_dwordx4 v114, s[4:7], s36 offen sc1 lds
    s_add_u32 s36, s36, 786432
    s_add_u32 m0, s37, 12288
    s_nop 0
    buffer_load_dwordx4 v114, s[4:7], s36 offen sc1 lds
    s_add_u32 s36, s36, 786432
    v_lshrrev_b32 v95, 4, v112
    v_lshlrev_b32 v95, 14, v95
    v_and_b32 v94, 15, v112
    v_lshl_add_u32 v95, v94, 4, v95
    s_add_u32 m0, s37, 24576
    s_nop 0
    buffer_load_dwordx4 v95, s[4:7], s47 offen sc1 lds
L_odma_donepb:
    s_waitcnt vmcnt(0)
L_ochkp:
    ds_read_b128 v[80:83], v115 offset:0
    ds_read_b128 v[84:87], v115 offset:12288
    ds_read_b128 v[88:91], v115 offset:24576
    s_waitcnt lgkmcnt(0)
    v_max3_u32 v80, v80, v81, v82
    v_max3_u32 v80, v80, v83, v84
    v_max3_u32 v80, v80, v85, v86
    v_max3_u32 v80, v80, v87, v88
    v_max3_u32 v80, v80, v89, v90
    v_max_u32 v80, v80, v91
    v_cmp_eq_u32 vcc, -1, v80
    s_sub_u32 s46, s46, 1
    s_cmp_eq_u32 s46, 0
    s_cbranch_scc1 L_odonep
    s_nop 2
    s_cbranch_vccnz L_oretryp
L_odonep:
    s_waitcnt vmcnt(0)
    s_barrier
    s_cmp_eq_u32 s13, 0
    s_cbranch_scc0 L_pu_1
    v_lshlrev_b32 v114, 4, v112
    v_and_b32 v115, 31, v112
    v_lshlrev_b32 v115, 3, v115
    v_lshrrev_b32 v96, 5, v112
    v_lshl_add_u32 v115, v96, 9, v115
    s_add_u32 s44, s44, 4096
    buffer_load_dwordx4 v[32:35], v113, s[4:7], s44 offen offset:0
    buffer_load_dwordx4 v[36:39], v113, s[4:7], s44 offen offset:1024
    ds_read_b128 v[80:83], v114 offset:0
    ds_read_b128 v[84:87], v114 offset:1024
    ds_read_b128 v[88:91], v114 offset:2048
    s_lshl_b32 s19, s8, 12
    s_add_u32 s19, s19, 40960
    v_add_u32 v113, s19, v113
    ds_read_b128 v[92:95], v114 offset:3072
    s_waitcnt lgkmcnt(3)
    v_mfma_f32_32x32x16_bf16 v[96:111], v[0:3], v[80:83], 0
    ds_read_b128 v[80:83], v114 offset:4096
    s_waitcnt lgkmcnt(3)
    v_mfma_f32_32x32x16_bf16 v[96:111], v[4:7], v[84:87], v[96:111]
    ds_read_b128 v[84:87], v114 offset:5120
    s_waitcnt lgkmcnt(3)
    v_mfma_f32_32x32x16_bf16 v[96:111], v[8:11], v[88:91], v[96:111]
    ds_read_b128 v[88:91], v114 offset:6144
    s_waitcnt lgkmcnt(3)
    v_mfma_f32_32x32x16_bf16 v[96:111], v[12:15], v[92:95], v[96:111]
    ds_read_b128 v[92:95], v114 offset:7168
    s_waitcnt lgkmcnt(3)
    v_mfma_f32_32x32x16_bf16 v[96:111], v[16:19], v[80:83], v[96:111]
    ds_read_b128 v[80:83], v114 offset:8192
    s_waitcnt lgkmcnt(3)
    v_mfma_f32_32x32x16_bf16 v[96:111], v[20:23], v[84:87], v[96:111]
    ds_read_b128 v[84:87], v114 offset:9216
    s_waitcnt lgkmcnt(3)
    v_mfma_f32_32x32x16_bf16 v[96:111], v[24:27], v[88:91], v[96:111]
    s_waitcnt lgkmcnt(2)
    v_mfma_f32_32x32x16_bf16 v[96:111], v[28:31], v[92:95], v[96:111]
    s_waitcnt vmcnt(1) lgkmcnt(1)
    v_mfma_f32_32x32x16_bf16 v[96:111], v[32:35], v[80:83], v[96:111]
    s_waitcnt vmcnt(0) lgkmcnt(0)
    v_mfma_f32_32x32x16_bf16 v[96:111], v[36:39], v[84:87], v[96:111]
    s_nop 15
    ds_write_b128 v113, v[96:99] offset:0
    ds_write_b128 v113, v[100:103] offset:1024
    ds_write_b128 v113, v[104:107] offset:2048
    ds_write_b128 v113, v[108:111] offset:3072
    s_waitcnt lgkmcnt(0)
    s_branch L_pu_done
L_pu_1:
    s_cmp_eq_u32 s13, 1
    s_cbranch_scc0 L_pu_2
    v_lshlrev_b32 v114, 4, v112
    v_and_b32 v115, 31, v112
    v_lshlrev_b32 v115, 3, v115
    v_lshrrev_b32 v96, 5, v112
    v_lshl_add_u32 v115, v96, 9, v115
    s_add_u32 s44, s44, 4096
    buffer_load_dwordx4 v[32:35], v113, s[4:7], s44 offen offset:0
    buffer_load_dwordx4 v[36:39], v113, s[4:7], s44 offen offset:1024
    ds_read_b128 v[80:83], v114 offset:10240
    ds_read_b128 v[84:87], v114 offset:11264
    ds_read_b128 v[88:91], v114 offset:12288
    s_lshl_b32 s19, s8, 12
    s_add_u32 s19, s19, 40960
    v_add_u32 v113, s19, v113
    ds_read_b128 v[92:95], v114 offset:13312
    s_waitcnt lgkmcnt(3)
    v_mfma_f32_32x32x16_bf16 v[96:111], v[0:3], v[80:83], 0
    ds_read_b128 v[80:83], v114 offset:14336
    s_waitcnt lgkmcnt(3)
    v_mfma_f32_32x32x16_bf16 v[96:111], v[4:7], v[84:87], v[96:111]
    ds_read_b128 v[84:87], v114 offset:15360
    s_waitcnt lgkmcnt(3)
    v_mfma_f32_32x32x16_bf16 v[96:111], v[8:11], v[88:91], v[96:111]
    ds_read_b128 v[88:91], v114 offset:16384
    s_waitcnt lgkmcnt(3)
    v_mfma_f32_32x32x16_bf16 v[96:111], v[12:15], v[92:95], v[96:111]
    ds_read_b128 v[92:95], v114 offset:17408
    s_waitcnt lgkmcnt(3)
    v_mfma_f32_32x32x16_bf16 v[96:111], v[16:19], v[80:83], v[96:111]
    ds_read_b128 v[80:83], v114 offset:18432
    s_waitcnt lgkmcnt(3)
    v_mfma_f32_32x32x16_bf16 v[96:111], v[20:23], v[84:87], v[96:111]
    ds_read_b128 v[84:87], v114 offset:19456
    s_waitcnt lgkmcnt(3)
    v_mfma_f32_32x32x16_bf16 v[96:111], v[24:27], v[88:91], v[96:111]
    s_waitcnt lgkmcnt(2)
    v_mfma_f32_32x32x16_bf16 v[96:111], v[28:31], v[92:95], v[96:111]
    s_waitcnt vmcnt(1) lgkmcnt(1)
    v_mfma_f32_32x32x16_bf16 v[96:111], v[32:35], v[80:83], v[96:111]
    s_waitcnt vmcnt(0) lgkmcnt(0)
    v_mfma_f32_32x32x16_bf16 v[96:111], v[36:39], v[84:87], v[96:111]
    s_nop 15
    ds_write_b128 v113, v[96:99] offset:0
    ds_write_b128 v113, v[100:103] offset:1024
    ds_write_b128 v113, v[104:107] offset:2048
    ds_write_b128 v113, v[108:111] offset:3072
    s_waitcnt lgkmcnt(0)
    s_branch L_pu_done
L_pu_2:
    s_cmp_eq_u32 s13, 2
    s_cbranch_scc0 L_pu_3
    v_lshlrev_b32 v114, 4, v112
    v_and_b32 v115, 31, v112
    v_lshlrev_b32 v115, 3, v115
    v_lshrrev_b32 v96, 5, v112
    v_lshl_add_u32 v115, v96, 9, v115
    s_add_u32 s44, s44, 4096
    buffer_load_dwordx4 v[32:35], v113, s[4:7], s44 offen offset:0
    buffer_load_dwordx4 v[36:39], v113, s[4:7], s44 offen offset:1024
    ds_read_b128 v[80:83], v114 offset:20480
    ds_read_b128 v[84:87], v114 offset:21504
    ds_read_b128 v[88:91], v114 offset:22528
    s_lshl_b32 s19, s8, 12
    s_add_u32 s19, s19, 40960
    v_add_u32 v113, s19, v113
    ds_read_b128 v[92:95], v114 offset:23552
    s_waitcnt lgkmcnt(3)
    v_mfma_f32_32x32x16_bf16 v[96:111], v[0:3], v[80:83], 0
    ds_read_b128 v[80:83], v114 offset:24576
    s_waitcnt lgkmcnt(3)
    v_mfma_f32_32x32x16_bf16 v[96:111], v[4:7], v[84:87], v[96:111]
    ds_read_b128 v[84:87], v114 offset:25600
    s_waitcnt lgkmcnt(3)
    v_mfma_f32_32x32x16_bf16 v[96:111], v[8:11], v[88:91], v[96:111]
    ds_read_b128 v[88:91], v114 offset:26624
    s_waitcnt lgkmcnt(3)
    v_mfma_f32_32x32x16_bf16 v[96:111], v[12:15], v[92:95], v[96:111]
    ds_read_b128 v[92:95], v114 offset:27648
    s_waitcnt lgkmcnt(3)
    v_mfma_f32_32x32x16_bf16 v[96:111], v[16:19], v[80:83], v[96:111]
    ds_read_b128 v[80:83], v114 offset:28672
    s_waitcnt lgkmcnt(3)
    v_mfma_f32_32x32x16_bf16 v[96:111], v[20:23], v[84:87], v[96:111]
    ds_read_b128 v[84:87], v114 offset:29696
    s_waitcnt lgkmcnt(3)
    v_mfma_f32_32x32x16_bf16 v[96:111], v[24:27], v[88:91], v[96:111]
    s_waitcnt lgkmcnt(2)
    v_mfma_f32_32x32x16_bf16 v[96:111], v[28:31], v[92:95], v[96:111]
    s_waitcnt vmcnt(1) lgkmcnt(1)
    v_mfma_f32_32x32x16_bf16 v[96:111], v[32:35], v[80:83], v[96:111]
    s_waitcnt vmcnt(0) lgkmcnt(0)
    v_mfma_f32_32x32x16_bf16 v[96:111], v[36:39], v[84:87], v[96:111]
    s_nop 15
    ds_write_b128 v113, v[96:99] offset:0
    ds_write_b128 v113, v[100:103] offset:1024
    ds_write_b128 v113, v[104:107] offset:2048
    ds_write_b128 v113, v[108:111] offset:3072
    s_waitcnt lgkmcnt(0)
    s_branch L_pu_done
L_pu_3:
    v_lshlrev_b32 v114, 4, v112
    v_and_b32 v115, 31, v112
    v_lshlrev_b32 v115, 3, v115
    v_lshrrev_b32 v96, 5, v112
    v_lshl_add_u32 v115, v96, 9, v115
    s_add_u32 s44, s44, 4096
    buffer_load_dwordx4 v[32:35], v113, s[4:7], s44 offen offset:0
    buffer_load_dwordx4 v[36:39], v113, s[4:7], s44 offen offset:1024
    ds_read_b128 v[80:83], v114 offset:30720
    ds_read_b128 v[84:87], v114 offset:31744
    ds_read_b64 v[88:89], v115 offset:32768
    ds_read_b64 v[90:91], v115 offset:33024
    s_lshl_b32 s19, s8, 12
    s_add_u32 s19, s19, 40960
    v_add_u32 v113, s19, v113
    ds_read_b64 v[92:93], v115 offset:33792
    ds_read_b64 v[94:95], v115 offset:34048
    s_waitcnt lgkmcnt(5)
    v_mfma_f32_32x32x16_bf16 v[96:111], v[0:3], v[80:83], 0
    ds_read_b64 v[80:81], v115 offset:34816
    ds_read_b64 v[82:83], v115 offset:35072
    s_waitcnt lgkmcnt(6)
    v_mfma_f32_32x32x16_bf16 v[96:111], v[4:7], v[84:87], v[96:111]
    ds_read_b64 v[84:85], v115 offset:35840
    ds_read_b64 v[86:87], v115 offset:36096
    s_waitcnt lgkmcnt(6)
    v_mfma_f32_32x32x16_bf16 v[96:111], v[8:11], v[88:91], v[96:111]
    ds_read_b64 v[88:89], v115 offset:36864
    ds_read_b64 v[90:91], v115 offset:37120
    s_waitcnt lgkmcnt(6)
    v_mfma_f32_32x32x16_bf16 v[96:111], v[12:15], v[92:95], v[96:111]
    ds_read_b64 v[92:93], v115 offset:37888
    ds_read_b64 v[94:95], v115 offset:38144
    s_waitcnt lgkmcnt(6)
    v_mfma_f32_32x32x16_bf16 v[96:111], v[16:19], v[80:83], v[96:111]
    ds_read_b64 v[80:81], v115 offset:38912
    ds_read_b64 v[82:83], v115 offset:39168
    s_waitcnt lgkmcnt(6)
    v_mfma_f32_32x32x16_bf16 v[96:111], v[20:23], v[84:87], v[96:111]
    ds_read_b64 v[84:85], v115 offset:39936
    ds_read_b64 v[86:87], v115 offset:40192
    s_waitcnt lgkmcnt(6)
    v_mfma_f32_32x32x16_bf16 v[96:111], v[24:27], v[88:91], v[96:111]
    s_waitcnt lgkmcnt(4)
    v_mfma_f32_32x32x16_bf16 v[96:111], v[28:31], v[92:95], v[96:111]
    s_waitcnt vmcnt(1) lgkmcnt(2)
    v_mfma_f32_32x32x16_bf16 v[96:111], v[32:35], v[80:83], v[96:111]
    s_waitcnt vmcnt(0) lgkmcnt(0)
    v_mfma_f32_32x32x16_bf16 v[96:111], v[36:39], v[84:87], v[96:111]
    s_nop 15
    ds_write_b128 v113, v[96:99] offset:0
    ds_write_b128 v113, v[100:103] offset:1024
    ds_write_b128 v113, v[104:107] offset:2048
    ds_write_b128 v113, v[108:111] offset:3072
    s_waitcnt lgkmcnt(0)
L_pu_done:
    s_barrier
    s_lshl_b32 s19, s13, 12
    s_add_u32 s19, s19, 40960
    v_add_u32 v154, s19, v152
    s_lshl_b32 s19, s13, 10
    s_add_u32 s19, s19, 73728
    v_add_u32 v155, s19, v152
    ds_read_b128 v[0:3], v154 offset:0
    ds_read_b128 v[4:7], v154 offset:1024
    ds_read_b128 v[8:11], v154 offset:2048
    ds_read_b128 v[12:15], v154 offset:3072
    ds_read_b128 v[16:19], v154 offset:16384
    ds_read_b128 v[20:23], v154 offset:17408
    ds_read_b128 v[24:27], v154 offset:18432
    ds_read_b128 v[28:31], v154 offset:19456
    ds_read_b128 v[32:35], v155 offset:0
    ds_read_b128 v[36:39], v155 offset:4096
    ds_read_b128 v[40:43], v155 offset:8192
    ds_read_b128 v[44:47], v155 offset:12288
    v_mul_u32_u24 v156, 1280, v159
    v_lshl_add_u32 v157, v160, 3, v156
    v_lshl_add_u32 v156, v160, 4, v156
    s_mul_i32 s36, s40, 40960
    s_mul_i32 s19, s41, 320
    s_add_u32 s36, s36, s19
    s_lshl_b32 s19, s13, 4
    s_add_u32 s37, s36, s19
    s_add_u32 s37, s37, 256
    s_lshl_b32 s19, s13, 6
    s_add_u32 s36, s36, s19
    s_waitcnt lgkmcnt(0)
    v_add_f32 v0, v0, v16
    v_add_f32 v1, v1, v17
    v_add_f32 v2, v2, v18
    v_add_f32 v3, v3, v19
    v_add_f32 v4, v4, v20
    v_add_f32 v5, v5, v21
    v_add_f32 v6, v6, v22
    v_add_f32 v7, v7, v23
    v_add_f32 v8, v8, v24
    v_add_f32 v9, v9, v25
    v_add_f32 v10, v10, v26
    v_add_f32 v11, v11, v27
    v_add_f32 v12, v12, v28
    v_add_f32 v13, v13, v29
    v_add_f32 v14, v14, v30
    v_add_f32 v15, v15, v31
    v_add_f32 v32, v32, v36
    v_add_f32 v40, v40, v44
    v_add_f32 v33, v33, v37
    v_add_f32 v41, v41, v45
    v_add_f32 v34, v34, v38
    v_add_f32 v42, v42, v46
    v_add_f32 v35, v35, v39
    v_add_f32 v43, v43, v47
    v_add_f32 v32, v32, v40
    v_add_f32 v33, v33, v41
    v_add_f32 v34, v34, v42
    v_add_f32 v35, v35, v43
    v_sub_f32 v0, v0, v130
    v_sub_f32 v1, v1, v131
    v_sub_f32 v2, v2, v132
    v_sub_f32 v3, v3, v133
    v_sub_f32 v4, v4, v134
    v_sub_f32 v5, v5, v135
    v_sub_f32 v6, v6, v136
    v_sub_f32 v7, v7, v137
    v_sub_f32 v8, v8, v138
    v_sub_f32 v9, v9, v139
    v_sub_f32 v10, v10, v140
    v_sub_f32 v11, v11, v141
    v_sub_f32 v12, v12, v142
    v_sub_f32 v13, v13, v143
    v_sub_f32 v14, v14, v144
    v_sub_f32 v15, v15, v145
    v_sub_f32 v32, v32, v146
    v_sub_f32 v33, v33, v147
    v_sub_f32 v34, v34, v148
    v_sub_f32 v35, v35, v149
    v_fma_f32 v0, v150, v0, v130
    v_fma_f32 v1, v150, v1, v131
    v_fma_f32 v2, v150, v2, v132
    v_fma_f32 v3, v150, v3, v133
    v_fma_f32 v4, v150, v4, v134
    v_fma_f32 v5, v150, v5, v135
    v_fma_f32 v6, v150, v6, v136
    v_fma_f32 v7, v150, v7, v137
    v_fma_f32 v8, v150, v8, v138
    v_fma_f32 v9, v150, v9, v139
    v_fma_f32 v10, v150, v10, v140
    v_fma_f32 v11, v150, v11, v141
    v_fma_f32 v12, v150, v12, v142
    v_fma_f32 v13, v150, v13, v143
    v_fma_f32 v14, v150, v14, v144
    v_fma_f32 v15, v150, v15, v145
    v_fma_f32 v32, v150, v32, v146
    v_fma_f32 v33, v150, v33, v147
    v_fma_f32 v34, v150, v34, v148
    v_fma_f32 v35, v150, v35, v149
    v_cvt_pk_bf16_f32 v48, v0, v1
    v_cvt_pk_bf16_f32 v49, v2, v3
    v_cvt_pk_bf16_f32 v50, v4, v5
    v_cvt_pk_bf16_f32 v51, v6, v7
    v_cvt_pk_bf16_f32 v52, v8, v9
    v_cvt_pk_bf16_f32 v53, v10, v11
    v_cvt_pk_bf16_f32 v54, v12, v13
    v_cvt_pk_bf16_f32 v55, v14, v15
    v_cvt_pk_bf16_f32 v56, v32, v33
    v_cvt_pk_bf16_f32 v57, v34, v35
    s_nop 1
    v_permlane32_swap_b32 v48, v50
    v_permlane32_swap_b32 v49, v51
    v_permlane32_swap_b32 v52, v54
    v_permlane32_swap_b32 v53, v55
    buffer_store_dwordx4 v[48:51], v156, s[48:51], s36 offen offset:0
    buffer_store_dwordx4 v[52:55], v156, s[48:51], s36 offen offset:32
    buffer_store_dwordx2 v[56:57], v157, s[48:51], s37 offen
    s_endpgm
L_attn_end:
    s_endpgm
L_code_end:
    s_nop 0
.section .rodata,"a"
.p2align 6
.amdhsa_kernel k1_kernel
  .amdhsa_next_free_vgpr 168
  .amdhsa_next_free_sgpr 96
  .amdhsa_accum_offset 168
  .amdhsa_group_segment_fixed_size 0
  .amdhsa_kernarg_size 88
  .amdhsa_user_sgpr_count 2
  .amdhsa_user_sgpr_kernarg_segment_ptr 1
  .amdhsa_system_sgpr_workgroup_id_x 1
  .amdhsa_float_denorm_mode_32 3
.end_amdhsa_kernel
.p2align 6
.amdhsa_kernel attn_kernel
  .amdhsa_next_free_vgpr 168
  .amdhsa_next_free_sgpr 96
  .amdhsa_accum_offset 168
  .amdhsa_group_segment_fixed_size 0
  .amdhsa_kernarg_size 88
  .amdhsa_user_sgpr_count 2
  .amdhsa_user_sgpr_kernarg_segment_ptr 1
  .amdhsa_system_sgpr_workgroup_id_x 1
  .amdhsa_float_denorm_mode_32 3
.end_amdhsa_kernel
```
